```python
import torch

def _softmax(x, axis=-1):
    return torch.softmax(x, dim=axis)
def _gelu(x):
    return torch.nn.functional.gelu(x, approximate="tanh")
def _silu(x):
    return torch.nn.functional.silu(x)
def _sigmoid(x):
    return torch.sigmoid(x)
def _layernorm(x, axis=-1, eps=1e-5):
    m = x.mean(dim=axis, keepdim=True)
    v = x.var(dim=axis, keepdim=True, unbiased=False)
    return (x - m) / torch.sqrt(v + eps)
def _scatter_add(tgt, idx, src, axis=0):
    return tgt.clone().index_add_(axis, idx, src)
def _segment_sum(src, seg, n):
    out = torch.zeros((n,) + src.shape[1:], dtype=src.dtype)
    return out.index_add_(0, seg, src)
def _pad(x, pw):
    flat = tuple(v for pair in reversed(pw) for v in pair)
    return torch.nn.functional.pad(x, flat)

kernel_name = 'sequential_preLN__grouped_kv_mqa__geglu_ffn__prompt'

def setup_inputs():

    _w = (lambda a: (lambda t: t.to(torch.bfloat16) if t.is_floating_point() else t)(torch.as_tensor(a)))
    def _A_setup():
        B, S, D, H = 1, 2048, 448, 16
        Dh = D // H
        return {
            "x": _w((lambda *s: torch.randn(*s, dtype=torch.bfloat16) * 0.05)(B, S, D)),
            "wq": _w((lambda *s: torch.randn(*s, dtype=torch.bfloat16) * 0.05)(D, H * Dh)),
            "wk": _w((lambda *s: torch.randn(*s, dtype=torch.bfloat16) * 0.05)(D, Dh)),
            "wv": _w((lambda *s: torch.randn(*s, dtype=torch.bfloat16) * 0.05)(D, Dh)),
            "wo": _w((lambda *s: torch.randn(*s, dtype=torch.bfloat16) * 0.05)(H * Dh, D)),
        }
    _A_in = _A_setup()

    def _B_setup():
        B, S, D, F = 1, 2048, 448, 1792
        return {
            "x": _w((lambda *s: torch.randn(*s, dtype=torch.bfloat16) * 0.05)(B, S, D)),
            "w_gate": _w((lambda *s: torch.randn(*s, dtype=torch.bfloat16) * 0.05)(D, F)),
            "w_up": _w((lambda *s: torch.randn(*s, dtype=torch.bfloat16) * 0.05)(D, F)),
            "w_down": _w((lambda *s: torch.randn(*s, dtype=torch.bfloat16) * 0.05)(F, D)),
        }
    _B_in = _B_setup()

    return {
        "A_x": _A_in["x"],
        "A_wq": _A_in["wq"],
        "A_wk": _A_in["wk"],
        "A_wv": _A_in["wv"],
        "A_wo": _A_in["wo"],
        "B_x": _B_in["x"],
        "B_w_gate": _B_in["w_gate"],
        "B_w_up": _B_in["w_up"],
        "B_w_down": _B_in["w_down"],
    }

def reference(A_x, A_wq, A_wk, A_wv, A_wo, B_x, B_w_gate, B_w_up, B_w_down):
    def _A_ref(x, wq, wk, wv, wo):
        B, S, D = x.shape
        H = 16
        Dh = D // H
        q = (lambda x, *d: x.permute(*d))((x @ wq).reshape(B, S, H, Dh), 0, 2, 1, 3)
        k = x @ wk
        v = x @ wv
        scores = torch.einsum("bhqd,bkd->bhqk", q, k) * (Dh ** -0.5)
        p = _softmax(scores, axis=-1)
        o = torch.einsum("bhqk,bkd->bhqd", p, v)
        return (lambda x, *d: x.permute(*d))(o, 0, 2, 1, 3).reshape(B, S, H * Dh) @ wo

    def _B_ref(x, w_gate, w_up, w_down):
        return (_gelu(x @ w_gate) * (x @ w_up)) @ w_down

    x = A_x
    h = x + _A_ref(_layernorm(x, axis=-1), A_wq, A_wk, A_wv, A_wo)
    h2 = h + _B_ref(_layernorm(h, axis=-1), B_w_gate, B_w_up, B_w_down)
    return h2
```

```asm
; @launch grid=(256,1,1) block=(256,1,1) lds=163840
.amdgcn_target "amdgcn-amd-amdhsa--gfx950"
.text
.globl sequential_preLN__grouped_kv_mqa__geglu_ffn__prompt_kernel
.p2align 12
.fill 320, 4, 0xbf810000
.p2align 8
.type sequential_preLN__grouped_kv_mqa__geglu_ffn__prompt_kernel,@function
sequential_preLN__grouped_kv_mqa__geglu_ffn__prompt_kernel:
    s_cmp_ge_u32 s2, 256
    s_cbranch_scc1 L_exit
    s_load_dwordx8 s[4:11], s[0:1], 0
    s_load_dwordx2 s[12:13], s[0:1], 32
    s_load_dwordx2 s[14:15], s[0:1], 88
    s_load_dwordx8 s[16:23], s[0:1], 48
    s_getpc_b64 s[84:85]
L_pc:
    s_lshr_b32 s72, s2, 3
    s_lshl_b32 s72, s72, 11
    v_lshrrev_b32 v1, 4, v0
    v_lshl_add_u32 v1, v1, 7, s72
    v_min_u32 v1, L_exit-L_pc, v1
    global_load_dword v62, v1, s[84:85]
    v_lshrrev_b32 v1, 6, v0
    v_and_b32 v0, 63, v0
    v_readfirstlane_b32 s61, v1
    s_and_b32 s64, s2, 7
    s_lshr_b32 s65, s2, 3
    s_lshl_b32 s60, s64, 5
    s_add_u32 s60, s60, s65
    s_lshr_b32 s62, s60, 2
    s_and_b32 s63, s60, 3
    v_lshlrev_b32 v1, 4, v0
    v_lshrrev_b32 v44, 3, v0
    v_and_b32 v45, 7, v0
    v_mul_u32_u24 v46, 896, v44
    v_lshl_add_u32 v46, v45, 4, v46
    s_mov_b32 s84, 0x06543210
    s_mov_b32 s85, 0x10654321
    s_lshl_b32 s81, s64, 2
    s_lshr_b64 s[84:85], s[84:85], s81
    s_mov_b32 s100, s84
    s_bfe_u32 s81, s84, 1572868
    s_lshl_b32 s84, s81, 24
    s_or_b32 s84, s84, s81
    s_lshr_b32 s85, s81, 8
    s_lshl_b32 s81, s81, 16
    s_or_b32 s85, s85, s81
    s_and_b32 s81, s65, 28
    s_lshr_b64 s[84:85], s[84:85], s81
    s_and_b32 s72, s100, 15
    s_lshl4_add_u32 s72, s84, s72
    s_lshl_b32 s73, s62, 2
    s_add_u32 s73, s73, s61
    s_mul_i32 s73, s73, 7168
    s_mov_b32 s30, 1835008
    s_mov_b32 s31, 0x00020000
    s_mov_b32 s35, 0x00020000
    s_waitcnt lgkmcnt(0)
    s_mov_b32 s28, s4
    s_mov_b32 s29, s5
    s_bfe_u32 s81, s72, 262144
    s_lshl_b32 s81, s81, 7
    s_add_u32 s81, s81, s73
    buffer_load_dwordx4 v[16:19], v46, s[28:31], s81 offen
    s_bfe_u32 s81, s72, 262148
    s_lshl_b32 s81, s81, 7
    s_add_u32 s81, s81, s73
    buffer_load_dwordx4 v[20:23], v46, s[28:31], s81 offen
    s_bfe_u32 s81, s72, 262152
    s_lshl_b32 s81, s81, 7
    s_add_u32 s81, s81, s73
    buffer_load_dwordx4 v[24:27], v46, s[28:31], s81 offen
    s_bfe_u32 s81, s72, 262156
    s_lshl_b32 s81, s81, 7
    s_add_u32 s81, s81, s73
    buffer_load_dwordx4 v[28:31], v46, s[28:31], s81 offen
    s_bfe_u32 s81, s72, 262160
    s_lshl_b32 s81, s81, 7
    s_add_u32 s81, s81, s73
    buffer_load_dwordx4 v[32:35], v46, s[28:31], s81 offen
    s_bfe_u32 s81, s72, 262164
    s_lshl_b32 s81, s81, 7
    s_add_u32 s81, s81, s73
    buffer_load_dwordx4 v[36:39], v46, s[28:31], s81 offen
    s_bfe_u32 s81, s72, 262168
    s_lshl_b32 s81, s81, 7
    s_add_u32 s81, s81, s73
    buffer_load_dwordx4 v[40:43], v46, s[28:31], s81 offen
    s_lshl_b32 s90, s63, 2
    s_add_u32 s90, s90, s61
    v_bfe_u32 v52, v0, 4, 1
    s_and_b32 s81, s61, 1
    s_lshr_b32 s75, s90, 1
    s_lshl_b32 s75, s75, 7
    s_mul_i32 s76, s81, 28672
    s_add_u32 s75, s75, s76
    s_mul_i32 s78, s61, 28672
    s_mul_i32 s81, s81, 24576
    v_lshlrev_b32 v54, 6, v52
    v_xor_b32 v47, v46, v54
    s_cmp_lt_u32 s90, 14
    s_cselect_b64 vcc, -1, 0
    s_cselect_b32 s75, s75, 0
    s_cselect_b32 s76, 6144, 0
    s_cselect_b32 s101, 1024, 0
    s_cselect_b32 s81, s81, 0
    s_cselect_b32 s82, 4, 0
    s_cselect_b32 s79, 1, 0
    v_cndmask_b32 v47, v1, v47, vcc
    s_sub_u32 s78, s78, s81
    s_lshl_b32 s77, 3584, s82
    s_lshl_b32 s34, 25088, s82
    s_lshl_b32 s79, 4096, s79
    s_cmp_eq_u32 s90, 14
    s_cselect_b32 s32, s8, s10
    s_cselect_b32 s33, s9, s11
    s_cmp_lt_u32 s90, 14
    s_cselect_b32 s32, s6, s32
    s_cselect_b32 s33, s7, s33
    s_bfe_u32 s74, s72, 262144
    s_mul_i32 s80, s74, s77
    s_mov_b32 m0, s78
    s_add_u32 s80, s80, s75
    buffer_load_dwordx4 v47, s[32:35], s80 offen offset:0 lds
    s_add_u32 s80, s80, s76
    buffer_load_dwordx4 v47, s[32:35], s80 offen offset:1024 lds
    s_add_u32 s80, s80, s76
    buffer_load_dwordx4 v47, s[32:35], s80 offen offset:2048 lds
    s_add_u32 s80, s80, s76
    buffer_load_dwordx4 v47, s[32:35], s80 offen offset:3072 lds
    s_load_dword s68, s[14:15], 0
    s_lshl_b32 s81, s60, 7
    s_load_dword s86, s[14:15], s81 offset:4096
    s_load_dword s86, s[14:15], s81 offset:36864
    s_load_dwordx2 s[86:87], s[14:15], s81 offset:131132
    s_lshl_b32 s82, s61, 6
    s_lshl1_add_u32 s81, s81, s82
    s_load_dword s86, s[14:15], s81 offset:262144
    s_mov_b32 s24, s14
    s_mov_b32 s25, s15
    s_mov_b32 s26, 15728640
    s_mov_b32 s27, 0x00020000
    v_bfe_u32 v49, v0, 2, 2
    v_and_b32 v50, 3, v0
    v_lshrrev_b32 v51, 5, v0
    v_lshl_add_u32 v53, v51, 3, v49
    v_and_b32 v56, 31, v0
    s_and_b32 s81, s61, 1
    s_and_b32 s82, s61, 2
    s_mul_i32 s82, s82, 28672
    v_lshrrev_b32 v54, 1, v49
    v_xor_b32 v54, s81, v54
    v_lshl_add_u32 v54, v54, 6, s82
    v_lshl_add_u32 v54, v53, 7, v54
    s_mul_i32 s82, s61, 28672
    v_mad_u32_u24 v48, v53, 56, s82
    v_lshl_add_u32 v48, v50, 3, v48
    v_mul_u32_u24 v57, 20, v50
    v_and_or_b32 v54, v57, 24, v54
    v_cndmask_b32 v48, v48, v54, vcc
    v_lshl_add_u32 v48, v52, 5, v48
    s_lshl_b32 s81, s61, 3
    v_xor_b32 v55, v44, v45
    v_add_u32 v55, s81, v55
    v_lshlrev_b32 v55, 4, v55
    v_lshl_add_u32 v55, v45, 9, v55
    v_add_u32 v55, 114688, v55
    v_lshrrev_b32 v54, 1, v0
    v_xor_b32 v54, v54, v0
    s_cmp_eq_u32 s90, 15
    s_cselect_b32 s81, 4, 0
    v_and_b32 v54, s81, v54
    v_mul_u32_u24 v54, 3, v54
    v_xor_b32 v58, v54, v56
    v_add_u32 v54, 0, v51
    v_xor_b32 v57, v58, v54
    v_lshlrev_b32 v57, 4, v57
    v_lshl_add_u32 v57, v54, 9, v57
    v_add_u32 v124, 114688, v57
    v_add_u32 v54, 2, v51
    v_xor_b32 v57, v58, v54
    v_lshlrev_b32 v57, 4, v57
    v_lshl_add_u32 v57, v54, 9, v57
    v_add_u32 v125, 114688, v57
    v_add_u32 v54, 4, v51
    v_xor_b32 v57, v58, v54
    v_lshlrev_b32 v57, 4, v57
    v_lshl_add_u32 v57, v54, 9, v57
    v_add_u32 v126, 114688, v57
    v_add_u32 v54, 6, v51
    v_xor_b32 v57, v58, v54
    v_lshlrev_b32 v57, 4, v57
    v_lshl_add_u32 v57, v54, 9, v57
    v_add_u32 v127, 114688, v57
    s_lshl_b32 s81, s61, 5
    s_add_u32 s81, s81, 163584
    v_lshl_add_u32 v59, v44, 2, s81
    v_bfe_u32 v61, v0, 3, 2
    v_mul_u32_u24 v61, 7168, v61
    v_lshl_add_u32 v61, v51, 7, v61
    v_lshl_add_u32 v61, v45, 4, v61
    s_mul_i32 s73, s62, 28672
    s_lshl_b32 s82, s90, 9
    s_add_u32 s73, s73, s82
    s_add_u32 s73, s73, 2097152
    s_lshl_b32 s82, s62, 12
    s_add_u32 s82, s82, 524288
    s_cmp_lt_u32 s90, 14
    s_cselect_b32 s73, s73, s82
    s_getreg_b32 s67, hwreg(HW_REG_XCC_ID, 0, 4)
    s_mul_i32 s71, s65, 37
    s_lshr_b32 s71, s71, 8
    s_mul_i32 s81, s71, 7
    s_sub_u32 s70, s65, s81
    s_mov_b32 s69, 0
    s_lshl_b32 s83, s60, 2
    s_add_u32 s83, s83, s61
    s_lshl_b32 s96, s83, 11
    s_add_u32 s96, s96, 6291456
    s_mov_b32 s81, 401408
    s_cmp_lt_u32 s83, 980
    s_cselect_b32 s81, s81, 0
    s_cselect_b32 s82, 15728640, 0
    s_mov_b32 s56, s14
    s_mov_b32 s57, s15
    s_mov_b32 s58, s82
    s_mov_b32 s59, 0x00020000
    s_cmp_lt_u32 s83, 784
    s_cselect_b32 s36, s20, s12
    s_cselect_b32 s37, s21, s13
    s_cselect_b32 s38, 1605632, s81
    s_mov_b32 s39, 0x00020000
    s_cselect_b32 s81, 0, 784
    s_cselect_b32 s95, 2, 0
    s_sub_u32 s83, s83, s81
    s_lshr_b32 s81, s83, s95
    s_mul_i32 s81, s81, 2341
    s_lshr_b32 s81, s81, 16
    s_mul_i32 s82, s81, 28
    s_lshl_b32 s82, s82, s95
    s_sub_u32 s82, s83, s82
    s_mul_i32 s94, s82, 14336
    s_lshl_b32 s81, s81, 7
    s_add_u32 s94, s94, s81
    s_add_u32 s95, s94, 6144
    s_lshl_b32 s97, s61, 11
    s_add_u32 s97, s97, 144384
    v_mov_b32 v234, v46
    v_and_b32 v54, 1, v50
    v_lshlrev_b32 v54, 4, v54
    v_lshrrev_b32 v57, 1, v50
    v_lshl_add_u32 v54, v57, 3, v54
    v_lshl_add_u32 v54, v53, 7, v54
    v_lshl_add_u32 v235, v52, 5, v54
    v_add_u32 v235, s97, v235
    v_bfe_u32 v57, v0, 3, 2
    v_lshl_add_u32 v249, v57, 5, v54
    v_mul_u32_u24 v54, 57344, v52
    v_add_u32 v249, v249, v54
    s_lshl_b32 s81, s61, 5
    v_xor_b32 v249, s81, v249
    v_xor_b32 v8, s81, v249
    v_xor_b32 v9, 32, v8
    v_xor_b32 v10, 64, v8
    v_xor_b32 v11, 96, v8
    s_cmp_lt_u32 s61, 2
    s_cselect_b32 s40, s16, s18
    s_cselect_b32 s41, s17, s19
    s_mov_b32 s43, 0x00020000
    s_cmp_lt_u32 s65, 28
    s_cselect_b32 s42, 1605632, 0
    s_cselect_b32 s82, 15728640, 0
    s_mov_b32 s44, s14
    s_mov_b32 s45, s15
    s_mov_b32 s46, s82
    s_mov_b32 s47, 0x00020000
    s_and_b32 s81, s61, 2
    v_or_b32 v54, s81, v52
    v_lshlrev_b32 v54, 1, v54
    v_xor_b32 v54, v45, v54
    v_mul_u32_u24 v233, 3584, v44
    v_lshl_add_u32 v233, v54, 4, v233
    s_and_b32 s81, s61, 1
    s_mul_i32 s98, s81, 802816
    s_lshl_b32 s81, s65, 7
    s_add_u32 s98, s98, s81
    v_add_u32 v233, s98, v233
    s_and_b32 s81, s100, 15
    s_mul_i32 s81, s81, 114688
    s_add_u32 s98, s98, s81
    s_mul_i32 s99, s61, 28672
    s_cmp_eq_u32 s61, 0
    s_cselect_b32 s82, 15728640, 0
    s_mov_b32 s52, s14
    s_mov_b32 s53, s15
    s_mov_b32 s54, s82
    s_mov_b32 s55, 0x00020000
    s_mov_b32 s48, s22
    s_mov_b32 s49, s23
    s_mov_b32 s50, 1835008
    s_mov_b32 s51, 0x00020000
    s_lshl_b32 s83, s64, 12
    s_add_u32 s83, s83, 131072
    s_lshl_b32 s4, s60, 7
    s_add_u32 s4, s4, 4096
    s_lshl_b32 s81, s65, 2
    s_add_u32 s5, s83, s81
    s_lshl_b32 s82, s61, 7
    s_add_u32 s20, s5, s82
    s_add_u32 s20, s20, 1024
    s_add_u32 s5, s5, 3072
    s_add_u32 s81, s81, s61
    s_lshl_b32 s81, s81, 2
    s_add_u32 s10, s83, s81
    s_add_u32 s10, s10, 3200
    s_lshr_b32 s81, s65, 2
    s_lshl_b32 s81, s81, 7
    s_add_u32 s16, s83, s81
    s_lshl_b32 s81, s90, 2
    s_add_u32 s16, s16, s81
    v_and_b32 v58, 15, v0
    s_add_u32 s82, s82, s83
    v_lshl_add_u32 v13, v58, 2, s82
    v_lshl_add_u32 v13, v52, 9, v13
    s_and_b32 s81, s65, 28
    s_add_u32 s81, s81, s61
    s_lshl_b32 s82, s81, 4
    s_add_u32 s82, s82, s83
    s_add_u32 s82, s82, 3200
    v_lshl_add_u32 v246, v50, 2, s82
    v_mov_b32 v57, s81
    s_lshl_b32 s81, s61, 3
    s_add_u32 s81, s81, 3
    v_and_b32 v54, 1, v0
    v_lshl_add_u32 v54, v54, 2, s81
    v_cmp_lt_u32 vcc, 1, v0
    s_add_u32 s81, s64, 1
    s_and_b32 s81, s81, 7
    v_cndmask_b32 v228, v54, v57, vcc
    s_add_u32 s82, s83, 3072
    v_lshl_add_u32 v228, v228, 2, s82
    s_lshl_b32 s81, s81, 12
    s_add_u32 s81, s81, 4096
    v_lshl_add_u32 v229, v54, 7, s81
    v_lshrrev_b32 v230, 1, v58
    v_lshl_add_u32 v230, v230, 5, v54
    s_lshl_b32 s81, s64, 5
    v_cmp_lt_u32 vcc, 15, v0
    v_add_u32 v57, s81, v57
    s_nop 0
    v_cndmask_b32 v230, v230, v57, vcc
    v_lshlrev_b32 v230, 7, v230
    v_add_u32 v230, 4096, v230
    s_mul_i32 s9, s60, 7168
    s_add_u32 s9, s9, 2097152
    s_lshl_b32 s81, s61, 11
    s_add_u32 s6, s9, s81
    s_mul_i32 s81, s61, 1792
    s_add_u32 s9, s9, s81
    s_lshl_b32 s7, s64, 2
    s_add_u32 s7, s7, s61
    s_lshl_b32 s7, s7, 13
    s_add_u32 s7, s7, 524288
    v_cmp_eq_u32 vcc, 0, v0
    v_mov_b32 v54, 0x7ff00000
    v_add_u32 v3, 4096, v1
    v_cndmask_b32 v2, v54, 0, vcc
    v_mov_b32 v5, s67
    s_mov_b32 s81, 0xffff0000
    s_waitcnt vmcnt(10)
    v_lshlrev_b32 v64, 16, v16
    v_and_b32 v65, s81, v16
    v_lshlrev_b32 v66, 16, v17
    v_and_b32 v67, s81, v17
    v_lshlrev_b32 v68, 16, v18
    v_and_b32 v69, s81, v18
    v_lshlrev_b32 v70, 16, v19
    v_and_b32 v71, s81, v19
    v_pk_add_f32 v[120:121], v[64:65], v[66:67]
    v_pk_add_f32 v[122:123], v[68:69], v[70:71]
    s_waitcnt vmcnt(9)
    v_lshlrev_b32 v72, 16, v20
    v_and_b32 v73, s81, v20
    v_lshlrev_b32 v74, 16, v21
    v_and_b32 v75, s81, v21
    v_lshlrev_b32 v76, 16, v22
    v_and_b32 v77, s81, v22
    v_lshlrev_b32 v78, 16, v23
    v_and_b32 v79, s81, v23
    v_pk_add_f32 v[120:121], v[120:121], v[72:73]
    v_pk_add_f32 v[122:123], v[122:123], v[74:75]
    v_pk_add_f32 v[120:121], v[120:121], v[76:77]
    v_pk_add_f32 v[122:123], v[122:123], v[78:79]
    s_waitcnt vmcnt(8)
    s_add_u32 s78, s78, s79
    s_bfe_u32 s74, s72, 262148
    s_mul_i32 s80, s74, s77
    s_mov_b32 m0, s78
    s_add_u32 s80, s80, s75
    buffer_load_dwordx4 v47, s[32:35], s80 offen offset:0 lds
    v_lshlrev_b32 v80, 16, v24
    v_and_b32 v81, s81, v24
    v_lshlrev_b32 v82, 16, v25
    v_and_b32 v83, s81, v25
    v_lshlrev_b32 v84, 16, v26
    v_and_b32 v85, s81, v26
    v_lshlrev_b32 v86, 16, v27
    v_and_b32 v87, s81, v27
    v_pk_add_f32 v[120:121], v[120:121], v[80:81]
    v_pk_add_f32 v[122:123], v[122:123], v[82:83]
    v_pk_add_f32 v[120:121], v[120:121], v[84:85]
    v_pk_add_f32 v[122:123], v[122:123], v[86:87]
    s_waitcnt vmcnt(8)
    s_add_u32 s80, s80, s76
    buffer_load_dwordx4 v47, s[32:35], s80 offen offset:1024 lds
    v_lshlrev_b32 v88, 16, v28
    v_and_b32 v89, s81, v28
    v_lshlrev_b32 v90, 16, v29
    v_and_b32 v91, s81, v29
    v_lshlrev_b32 v92, 16, v30
    v_and_b32 v93, s81, v30
    v_lshlrev_b32 v94, 16, v31
    v_and_b32 v95, s81, v31
    v_pk_add_f32 v[120:121], v[120:121], v[88:89]
    v_pk_add_f32 v[122:123], v[122:123], v[90:91]
    v_pk_add_f32 v[120:121], v[120:121], v[92:93]
    v_pk_add_f32 v[122:123], v[122:123], v[94:95]
    s_waitcnt vmcnt(8)
    s_add_u32 s80, s80, s76
    buffer_load_dwordx4 v47, s[32:35], s80 offen offset:2048 lds
    v_lshlrev_b32 v96, 16, v32
    v_and_b32 v97, s81, v32
    v_lshlrev_b32 v98, 16, v33
    v_and_b32 v99, s81, v33
    v_lshlrev_b32 v100, 16, v34
    v_and_b32 v101, s81, v34
    v_lshlrev_b32 v102, 16, v35
    v_and_b32 v103, s81, v35
    v_pk_add_f32 v[120:121], v[120:121], v[96:97]
    v_pk_add_f32 v[122:123], v[122:123], v[98:99]
    v_pk_add_f32 v[120:121], v[120:121], v[100:101]
    v_pk_add_f32 v[122:123], v[122:123], v[102:103]
    s_waitcnt vmcnt(8)
    s_add_u32 s80, s80, s76
    buffer_load_dwordx4 v47, s[32:35], s80 offen offset:3072 lds
    v_lshlrev_b32 v104, 16, v36
    v_and_b32 v105, s81, v36
    v_lshlrev_b32 v106, 16, v37
    v_and_b32 v107, s81, v37
    v_lshlrev_b32 v108, 16, v38
    v_and_b32 v109, s81, v38
    v_lshlrev_b32 v110, 16, v39
    v_and_b32 v111, s81, v39
    v_pk_add_f32 v[120:121], v[120:121], v[104:105]
    v_pk_add_f32 v[122:123], v[122:123], v[106:107]
    v_pk_add_f32 v[120:121], v[120:121], v[108:109]
    v_pk_add_f32 v[122:123], v[122:123], v[110:111]
    s_waitcnt vmcnt(8)
    s_add_u32 s78, s78, s79
    s_bfe_u32 s74, s72, 262152
    s_mul_i32 s80, s74, s77
    s_mov_b32 m0, s78
    s_add_u32 s80, s80, s75
    buffer_load_dwordx4 v47, s[32:35], s80 offen offset:0 lds
    v_lshlrev_b32 v112, 16, v40
    v_and_b32 v113, s81, v40
    v_lshlrev_b32 v114, 16, v41
    v_and_b32 v115, s81, v41
    v_lshlrev_b32 v116, 16, v42
    v_and_b32 v117, s81, v42
    v_lshlrev_b32 v118, 16, v43
    v_and_b32 v119, s81, v43
    v_pk_add_f32 v[120:121], v[120:121], v[112:113]
    v_pk_add_f32 v[122:123], v[122:123], v[114:115]
    v_pk_add_f32 v[120:121], v[120:121], v[116:117]
    v_pk_add_f32 v[122:123], v[122:123], v[118:119]
    v_pk_add_f32 v[120:121], v[120:121], v[122:123]
    v_add_f32 v120, v120, v121
    s_nop 1
    v_add_f32_dpp v120, v120, v120 quad_perm:[1,0,3,2] row_mask:0xf bank_mask:0xf
    s_nop 1
    v_add_f32_dpp v120, v120, v120 quad_perm:[2,3,0,1] row_mask:0xf bank_mask:0xf
    s_nop 1
    v_add_f32_dpp v120, v120, v120 row_half_mirror row_mask:0xf bank_mask:0xf
    v_mul_f32 v120, 0xbb124925, v120
    v_pk_add_f32 v[64:65], v[64:65], v[120:121] op_sel_hi:[1,0]
    v_pk_add_f32 v[66:67], v[66:67], v[120:121] op_sel_hi:[1,0]
    v_pk_add_f32 v[68:69], v[68:69], v[120:121] op_sel_hi:[1,0]
    v_pk_add_f32 v[70:71], v[70:71], v[120:121] op_sel_hi:[1,0]
    v_cvt_pk_bf16_f32 v16, v64, v65
    v_cvt_pk_bf16_f32 v17, v66, v67
    v_cvt_pk_bf16_f32 v18, v68, v69
    v_cvt_pk_bf16_f32 v19, v70, v71
    ds_write_b128 v55, v[16:19] offset:0
    v_pk_add_f32 v[72:73], v[72:73], v[120:121] op_sel_hi:[1,0]
    v_pk_add_f32 v[74:75], v[74:75], v[120:121] op_sel_hi:[1,0]
    v_pk_add_f32 v[76:77], v[76:77], v[120:121] op_sel_hi:[1,0]
    v_pk_add_f32 v[78:79], v[78:79], v[120:121] op_sel_hi:[1,0]
    v_cvt_pk_bf16_f32 v20, v72, v73
    v_cvt_pk_bf16_f32 v21, v74, v75
    v_cvt_pk_bf16_f32 v22, v76, v77
    v_cvt_pk_bf16_f32 v23, v78, v79
    ds_write_b128 v55, v[20:23] offset:4096
    v_pk_add_f32 v[80:81], v[80:81], v[120:121] op_sel_hi:[1,0]
    v_pk_add_f32 v[82:83], v[82:83], v[120:121] op_sel_hi:[1,0]
    v_pk_add_f32 v[84:85], v[84:85], v[120:121] op_sel_hi:[1,0]
    v_pk_add_f32 v[86:87], v[86:87], v[120:121] op_sel_hi:[1,0]
    v_cvt_pk_bf16_f32 v24, v80, v81
    v_cvt_pk_bf16_f32 v25, v82, v83
    v_cvt_pk_bf16_f32 v26, v84, v85
    v_cvt_pk_bf16_f32 v27, v86, v87
    ds_write_b128 v55, v[24:27] offset:8192
    v_pk_add_f32 v[88:89], v[88:89], v[120:121] op_sel_hi:[1,0]
    v_pk_add_f32 v[90:91], v[90:91], v[120:121] op_sel_hi:[1,0]
    v_pk_add_f32 v[92:93], v[92:93], v[120:121] op_sel_hi:[1,0]
    v_pk_add_f32 v[94:95], v[94:95], v[120:121] op_sel_hi:[1,0]
    v_cvt_pk_bf16_f32 v28, v88, v89
    v_cvt_pk_bf16_f32 v29, v90, v91
    v_cvt_pk_bf16_f32 v30, v92, v93
    v_cvt_pk_bf16_f32 v31, v94, v95
    ds_write_b128 v55, v[28:31] offset:12288
    s_add_u32 s80, s80, s76
    buffer_load_dwordx4 v47, s[32:35], s80 offen offset:1024 lds
    v_pk_add_f32 v[96:97], v[96:97], v[120:121] op_sel_hi:[1,0]
    v_pk_add_f32 v[98:99], v[98:99], v[120:121] op_sel_hi:[1,0]
    v_pk_add_f32 v[100:101], v[100:101], v[120:121] op_sel_hi:[1,0]
    v_pk_add_f32 v[102:103], v[102:103], v[120:121] op_sel_hi:[1,0]
    v_cvt_pk_bf16_f32 v32, v96, v97
    v_cvt_pk_bf16_f32 v33, v98, v99
    v_cvt_pk_bf16_f32 v34, v100, v101
    v_cvt_pk_bf16_f32 v35, v102, v103
    ds_write_b128 v55, v[32:35] offset:16384
    s_add_u32 s80, s80, s76
    buffer_load_dwordx4 v47, s[32:35], s80 offen offset:2048 lds
    v_pk_add_f32 v[104:105], v[104:105], v[120:121] op_sel_hi:[1,0]
    v_pk_add_f32 v[106:107], v[106:107], v[120:121] op_sel_hi:[1,0]
    v_pk_add_f32 v[108:109], v[108:109], v[120:121] op_sel_hi:[1,0]
    v_pk_add_f32 v[110:111], v[110:111], v[120:121] op_sel_hi:[1,0]
    v_cvt_pk_bf16_f32 v36, v104, v105
    v_cvt_pk_bf16_f32 v37, v106, v107
    v_cvt_pk_bf16_f32 v38, v108, v109
    v_cvt_pk_bf16_f32 v39, v110, v111
    ds_write_b128 v55, v[36:39] offset:20480
    s_add_u32 s80, s80, s76
    buffer_load_dwordx4 v47, s[32:35], s80 offen offset:3072 lds
    v_pk_add_f32 v[112:113], v[112:113], v[120:121] op_sel_hi:[1,0]
    v_pk_add_f32 v[114:115], v[114:115], v[120:121] op_sel_hi:[1,0]
    v_pk_add_f32 v[116:117], v[116:117], v[120:121] op_sel_hi:[1,0]
    v_pk_add_f32 v[118:119], v[118:119], v[120:121] op_sel_hi:[1,0]
    v_cvt_pk_bf16_f32 v40, v112, v113
    v_cvt_pk_bf16_f32 v41, v114, v115
    v_cvt_pk_bf16_f32 v42, v116, v117
    v_cvt_pk_bf16_f32 v43, v118, v119
    ds_write_b128 v55, v[40:43] offset:24576
    s_add_u32 s78, s78, s79
    s_bfe_u32 s74, s72, 262156
    s_mul_i32 s80, s74, s77
    s_mov_b32 m0, s78
    s_add_u32 s80, s80, s75
    buffer_load_dwordx4 v47, s[32:35], s80 offen offset:0 lds
    v_pk_mul_f32 v[120:121], v[64:65], v[64:65]
    v_pk_mul_f32 v[122:123], v[66:67], v[66:67]
    s_add_u32 s80, s80, s76
    buffer_load_dwordx4 v47, s[32:35], s80 offen offset:1024 lds
    s_add_u32 s80, s80, s76
    buffer_load_dwordx4 v47, s[32:35], s80 offen offset:2048 lds
    s_waitcnt lgkmcnt(0)
    s_mul_i32 s66, s68, 0x9E3779B1
    s_add_u32 s66, s66, 0x7F4A7C15
    s_cmp_eq_u32 s90, 14
    s_cbranch_scc1 L_g_k_1
    s_cmp_eq_u32 s90, 15
    s_cbranch_scc1 L_g_v_2
    s_waitcnt vmcnt(11)
    s_barrier
    ds_read_b128 v[172:175], v124 offset:0
    ds_read_b64_tr_b16 v[144:145], v48 offset:0
    ds_read_b64_tr_b16 v[146:147], v48 offset:512
    ds_read_b128 v[176:179], v125 offset:0
    ds_read_b64_tr_b16 v[148:149], v48 offset:2048
    ds_read_b64_tr_b16 v[150:151], v48 offset:2560
    ds_read_b128 v[180:183], v126 offset:0
    ds_read_b64_tr_b16 v[152:153], v48 offset:4096
    ds_read_b64_tr_b16 v[154:155], v48 offset:4608
    ds_read_b128 v[184:187], v127 offset:0
    ds_read_b64_tr_b16 v[156:157], v48 offset:6144
    ds_read_b64_tr_b16 v[158:159], v48 offset:6656
    s_add_u32 s80, s80, s76
    buffer_load_dwordx4 v47, s[32:35], s80 offen offset:3072 lds
    s_add_u32 s78, s78, s79
    s_bfe_u32 s74, s72, 262160
    s_mul_i32 s80, s74, s77
    s_mov_b32 m0, s78
    s_add_u32 s80, s80, s75
    buffer_load_dwordx4 v47, s[32:35], s80 offen offset:0 lds
    s_add_u32 s80, s80, s76
    buffer_load_dwordx4 v47, s[32:35], s80 offen offset:1024 lds
    s_add_u32 s80, s80, s76
    buffer_load_dwordx4 v47, s[32:35], s80 offen offset:2048 lds
    v_pk_fma_f32 v[120:121], v[68:69], v[68:69], v[120:121]
    v_pk_fma_f32 v[122:123], v[70:71], v[70:71], v[122:123]
    v_pk_fma_f32 v[120:121], v[72:73], v[72:73], v[120:121]
    v_pk_fma_f32 v[122:123], v[74:75], v[74:75], v[122:123]
    v_pk_fma_f32 v[120:121], v[76:77], v[76:77], v[120:121]
    v_pk_fma_f32 v[122:123], v[78:79], v[78:79], v[122:123]
    v_pk_fma_f32 v[120:121], v[80:81], v[80:81], v[120:121]
    v_pk_fma_f32 v[122:123], v[82:83], v[82:83], v[122:123]
    s_waitcnt lgkmcnt(9)
    v_mfma_f32_32x32x16_bf16 v[128:143], v[144:147], v[172:175], 0
    s_add_u32 s80, s80, s76
    buffer_load_dwordx4 v47, s[32:35], s80 offen offset:3072 lds
    s_waitcnt vmcnt(12)
    s_barrier
    ds_read_b128 v[188:191], v124 offset:4096
    ds_read_b64_tr_b16 v[160:161], v48 offset:8192
    ds_read_b64_tr_b16 v[162:163], v48 offset:8704
    v_fmac_f32 v120, v84, v84
    v_fmac_f32 v121, v85, v85
    v_fmac_f32 v122, v86, v86
    v_fmac_f32 v123, v87, v87
    s_waitcnt lgkmcnt(9)
    v_mfma_f32_32x32x16_bf16 v[128:143], v[148:151], v[176:179], v[128:143]
    s_add_u32 s78, s78, s79
    s_bfe_u32 s74, s72, 262164
    s_mul_i32 s80, s74, s77
    s_mov_b32 m0, s78
    s_add_u32 s80, s80, s75
    buffer_load_dwordx4 v47, s[32:35], s80 offen offset:0 lds
    ds_read_b128 v[172:175], v125 offset:4096
    ds_read_b64_tr_b16 v[144:145], v48 offset:10240
    ds_read_b64_tr_b16 v[146:147], v48 offset:10752
    v_fmac_f32 v120, v88, v88
    v_fmac_f32 v121, v89, v89
    v_fmac_f32 v122, v90, v90
    v_fmac_f32 v123, v91, v91
    s_waitcnt lgkmcnt(9)
    v_mfma_f32_32x32x16_bf16 v[128:143], v[152:155], v[180:183], v[128:143]
    s_add_u32 s80, s80, s76
    buffer_load_dwordx4 v47, s[32:35], s80 offen offset:1024 lds
    ds_read_b128 v[176:179], v126 offset:4096
    ds_read_b64_tr_b16 v[148:149], v48 offset:12288
    ds_read_b64_tr_b16 v[150:151], v48 offset:12800
    v_fmac_f32 v120, v92, v92
    v_fmac_f32 v121, v93, v93
    v_fmac_f32 v122, v94, v94
    v_fmac_f32 v123, v95, v95
    s_waitcnt lgkmcnt(9)
    v_mfma_f32_32x32x16_bf16 v[128:143], v[156:159], v[184:187], v[128:143]
    s_add_u32 s80, s80, s76
    buffer_load_dwordx4 v47, s[32:35], s80 offen offset:2048 lds
    ds_read_b128 v[180:183], v127 offset:4096
    ds_read_b64_tr_b16 v[152:153], v48 offset:14336
    ds_read_b64_tr_b16 v[154:155], v48 offset:14848
    v_fmac_f32 v120, v96, v96
    v_fmac_f32 v121, v97, v97
    v_fmac_f32 v122, v98, v98
    v_fmac_f32 v123, v99, v99
    s_waitcnt lgkmcnt(9)
    v_mfma_f32_32x32x16_bf16 v[128:143], v[160:163], v[188:191], v[128:143]
    s_add_u32 s80, s80, s76
    buffer_load_dwordx4 v47, s[32:35], s80 offen offset:3072 lds
    s_waitcnt vmcnt(8)
    s_barrier
    ds_read_b128 v[184:187], v124 offset:8192
    ds_read_b64_tr_b16 v[156:157], v48 offset:16384
    ds_read_b64_tr_b16 v[158:159], v48 offset:16896
    v_fmac_f32 v120, v100, v100
    v_fmac_f32 v121, v101, v101
    v_fmac_f32 v122, v102, v102
    v_fmac_f32 v123, v103, v103
    s_waitcnt lgkmcnt(9)
    v_mfma_f32_32x32x16_bf16 v[128:143], v[144:147], v[172:175], v[128:143]
    s_add_u32 s78, s78, s79
    s_bfe_u32 s74, s72, 262168
    s_mul_i32 s80, s74, s77
    s_mov_b32 m0, s78
    s_add_u32 s80, s80, s75
    buffer_load_dwordx4 v47, s[32:35], s80 offen offset:0 lds
    ds_read_b128 v[188:191], v125 offset:8192
    ds_read_b64_tr_b16 v[160:161], v48 offset:18432
    ds_read_b64_tr_b16 v[162:163], v48 offset:18944
    v_fmac_f32 v120, v104, v104
    v_fmac_f32 v121, v105, v105
    v_fmac_f32 v122, v106, v106
    v_fmac_f32 v123, v107, v107
    s_waitcnt lgkmcnt(9)
    v_mfma_f32_32x32x16_bf16 v[128:143], v[148:151], v[176:179], v[128:143]
    s_add_u32 s80, s80, s76
    buffer_load_dwordx4 v47, s[32:35], s80 offen offset:1024 lds
    ds_read_b128 v[172:175], v126 offset:8192
    ds_read_b64_tr_b16 v[144:145], v48 offset:20480
    ds_read_b64_tr_b16 v[146:147], v48 offset:20992
    v_fmac_f32 v120, v108, v108
    v_fmac_f32 v121, v109, v109
    v_fmac_f32 v122, v110, v110
    v_fmac_f32 v123, v111, v111
    s_waitcnt lgkmcnt(9)
    v_mfma_f32_32x32x16_bf16 v[128:143], v[152:155], v[180:183], v[128:143]
    s_add_u32 s80, s80, s76
    buffer_load_dwordx4 v47, s[32:35], s80 offen offset:2048 lds
    ds_read_b128 v[176:179], v127 offset:8192
    ds_read_b64_tr_b16 v[148:149], v48 offset:22528
    ds_read_b64_tr_b16 v[150:151], v48 offset:23040
    v_fmac_f32 v120, v112, v112
    v_fmac_f32 v121, v113, v113
    v_fmac_f32 v122, v114, v114
    v_fmac_f32 v123, v115, v115
    s_waitcnt lgkmcnt(9)
    v_mfma_f32_32x32x16_bf16 v[128:143], v[156:159], v[184:187], v[128:143]
    s_add_u32 s80, s80, s76
    buffer_load_dwordx4 v47, s[32:35], s80 offen offset:3072 lds
    ds_read_b128 v[180:183], v124 offset:12288
    ds_read_b64_tr_b16 v[152:153], v48 offset:24576
    ds_read_b64_tr_b16 v[154:155], v48 offset:25088
    v_fmac_f32 v120, v116, v116
    v_fmac_f32 v121, v117, v117
    v_fmac_f32 v122, v118, v118
    v_fmac_f32 v123, v119, v119
    s_waitcnt lgkmcnt(9)
    v_mfma_f32_32x32x16_bf16 v[128:143], v[160:163], v[188:191], v[128:143]
    ds_read_b128 v[184:187], v125 offset:12288
    ds_read_b64_tr_b16 v[156:157], v48 offset:26624
    ds_read_b64_tr_b16 v[158:159], v48 offset:27136
    v_add_f32 v120, v120, v121
    v_add_f32 v122, v122, v123
    v_add_f32 v120, v120, v122
    v_mov_b32 v121, 0x3727c5ac
    s_waitcnt lgkmcnt(9)
    v_mfma_f32_32x32x16_bf16 v[128:143], v[144:147], v[172:175], v[128:143]
    ds_read_b128 v[188:191], v126 offset:12288
    ds_read_b64_tr_b16 v[160:161], v48 offset:28672
    ds_read_b64_tr_b16 v[162:163], v48 offset:29184
    v_lshlrev_b32 v60, 2, v56
    v_add_f32_dpp v120, v120, v120 quad_perm:[1,0,3,2] row_mask:0xf bank_mask:0xf
    s_waitcnt lgkmcnt(9)
    v_mfma_f32_32x32x16_bf16 v[128:143], v[148:151], v[176:179], v[128:143]
    ds_read_b128 v[172:175], v127 offset:12288
    ds_read_b64_tr_b16 v[144:145], v48 offset:30720
    ds_read_b64_tr_b16 v[146:147], v48 offset:31232
    v_add_f32_dpp v120, v120, v120 quad_perm:[2,3,0,1] row_mask:0xf bank_mask:0xf
    s_waitcnt lgkmcnt(9)
    v_mfma_f32_32x32x16_bf16 v[128:143], v[152:155], v[180:183], v[128:143]
    s_waitcnt vmcnt(8)
    s_barrier
    ds_read_b128 v[176:179], v124 offset:16384
    ds_read_b64_tr_b16 v[148:149], v48 offset:32768
    ds_read_b64_tr_b16 v[150:151], v48 offset:33280
    v_add_f32_dpp v120, v120, v120 row_half_mirror row_mask:0xf bank_mask:0xf
    v_fmamk_f32 v120, v120, 0x3b124925, v121
    v_rsq_f32 v120, v120
    v_add_u32 v60, 163584, v60
    s_waitcnt lgkmcnt(9)
    v_mfma_f32_32x32x16_bf16 v[128:143], v[156:159], v[184:187], v[128:143]
    ds_read_b128 v[180:183], v125 offset:16384
    ds_read_b64_tr_b16 v[152:153], v48 offset:34816
    ds_read_b64_tr_b16 v[154:155], v48 offset:35328
    ds_write_b32 v59, v120
    s_waitcnt lgkmcnt(10)
    v_mfma_f32_32x32x16_bf16 v[128:143], v[160:163], v[188:191], v[128:143]
    ds_read_b128 v[184:187], v126 offset:16384
    ds_read_b64_tr_b16 v[156:157], v48 offset:36864
    ds_read_b64_tr_b16 v[158:159], v48 offset:37376
    s_waitcnt lgkmcnt(10)
    v_mfma_f32_32x32x16_bf16 v[128:143], v[144:147], v[172:175], v[128:143]
    ds_read_b128 v[188:191], v127 offset:16384
    ds_read_b64_tr_b16 v[160:161], v48 offset:38912
    ds_read_b64_tr_b16 v[162:163], v48 offset:39424
    s_waitcnt lgkmcnt(10)
    v_mfma_f32_32x32x16_bf16 v[128:143], v[148:151], v[176:179], v[128:143]
    s_waitcnt vmcnt(4) lgkmcnt(6)
    s_barrier
    ds_read_b128 v[172:175], v124 offset:20480
    ds_read_b64_tr_b16 v[144:145], v48 offset:40960
    ds_read_b64_tr_b16 v[146:147], v48 offset:41472
    v_mfma_f32_32x32x16_bf16 v[128:143], v[152:155], v[180:183], v[128:143]
    ds_read_b128 v[176:179], v125 offset:20480
    ds_read_b64_tr_b16 v[148:149], v48 offset:43008
    ds_read_b64_tr_b16 v[150:151], v48 offset:43520
    s_waitcnt lgkmcnt(9)
    v_mfma_f32_32x32x16_bf16 v[128:143], v[156:159], v[184:187], v[128:143]
    ds_read_b128 v[180:183], v126 offset:20480
    ds_read_b64_tr_b16 v[152:153], v48 offset:45056
    ds_read_b64_tr_b16 v[154:155], v48 offset:45568
    s_waitcnt lgkmcnt(9)
    v_mfma_f32_32x32x16_bf16 v[128:143], v[160:163], v[188:191], v[128:143]
    ds_read_b128 v[184:187], v127 offset:20480
    ds_read_b64_tr_b16 v[156:157], v48 offset:47104
    ds_read_b64_tr_b16 v[158:159], v48 offset:47616
    s_waitcnt lgkmcnt(9)
    v_mfma_f32_32x32x16_bf16 v[128:143], v[144:147], v[172:175], v[128:143]
    s_waitcnt vmcnt(0)
    s_barrier
    ds_read_b128 v[188:191], v124 offset:24576
    ds_read_b64_tr_b16 v[160:161], v48 offset:49152
    ds_read_b64_tr_b16 v[162:163], v48 offset:49664
    s_waitcnt lgkmcnt(9)
    v_mfma_f32_32x32x16_bf16 v[128:143], v[148:151], v[176:179], v[128:143]
    ds_read_b128 v[172:175], v125 offset:24576
    ds_read_b64_tr_b16 v[144:145], v48 offset:51200
    ds_read_b64_tr_b16 v[146:147], v48 offset:51712
    s_waitcnt lgkmcnt(9)
    v_mfma_f32_32x32x16_bf16 v[128:143], v[152:155], v[180:183], v[128:143]
    ds_read_b128 v[176:179], v126 offset:24576
    ds_read_b64_tr_b16 v[148:149], v48 offset:53248
    ds_read_b64_tr_b16 v[150:151], v48 offset:53760
    s_waitcnt lgkmcnt(9)
    v_mfma_f32_32x32x16_bf16 v[128:143], v[156:159], v[184:187], v[128:143]
    ds_read_b128 v[180:183], v127 offset:24576
    ds_read_b64_tr_b16 v[152:153], v48 offset:55296
    ds_read_b64_tr_b16 v[154:155], v48 offset:55808
    s_waitcnt lgkmcnt(9)
    v_mfma_f32_32x32x16_bf16 v[128:143], v[160:163], v[188:191], v[128:143]
    ds_read_b32 v196, v60
    s_waitcnt lgkmcnt(7)
    v_mfma_f32_32x32x16_bf16 v[128:143], v[144:147], v[172:175], v[128:143]
    s_waitcnt lgkmcnt(4)
    v_mfma_f32_32x32x16_bf16 v[128:143], v[148:151], v[176:179], v[128:143]
    s_waitcnt lgkmcnt(1)
    v_mfma_f32_32x32x16_bf16 v[128:143], v[152:155], v[180:183], v[128:143]
    s_waitcnt lgkmcnt(0)
    s_nop 10
    v_pk_mul_f32 v[128:129], v[128:129], v[196:197] op_sel_hi:[1,0]
    v_pk_mul_f32 v[130:131], v[130:131], v[196:197] op_sel_hi:[1,0]
    v_cvt_pk_bf16_f32 v144, v128, v129
    v_cvt_pk_bf16_f32 v145, v130, v131
    v_pk_mul_f32 v[132:133], v[132:133], v[196:197] op_sel_hi:[1,0]
    v_pk_mul_f32 v[134:135], v[134:135], v[196:197] op_sel_hi:[1,0]
    v_cvt_pk_bf16_f32 v146, v132, v133
    v_cvt_pk_bf16_f32 v147, v134, v135
    buffer_store_dwordx4 v[144:147], v61, s[24:27], s73 offen offset:0 sc1
    v_pk_mul_f32 v[136:137], v[136:137], v[196:197] op_sel_hi:[1,0]
    v_pk_mul_f32 v[138:139], v[138:139], v[196:197] op_sel_hi:[1,0]
    v_cvt_pk_bf16_f32 v148, v136, v137
    v_cvt_pk_bf16_f32 v149, v138, v139
    v_pk_mul_f32 v[140:141], v[140:141], v[196:197] op_sel_hi:[1,0]
    v_pk_mul_f32 v[142:143], v[142:143], v[196:197] op_sel_hi:[1,0]
    v_cvt_pk_bf16_f32 v150, v140, v141
    v_cvt_pk_bf16_f32 v151, v142, v143
    buffer_store_dwordx4 v[148:151], v61, s[24:27], s73 offen offset:256 sc1
    s_branch L_g_end_3
L_g_k_1:
    s_waitcnt vmcnt(11)
    s_barrier
    ds_read_b128 v[172:175], v124 offset:0
    ds_read_b64_tr_b16 v[144:145], v48 offset:0
    ds_read_b64_tr_b16 v[146:147], v48 offset:224
    ds_read_b128 v[176:179], v125 offset:0
    ds_read_b64_tr_b16 v[148:149], v48 offset:896
    ds_read_b64_tr_b16 v[150:151], v48 offset:1120
    ds_read_b128 v[180:183], v126 offset:0
    ds_read_b64_tr_b16 v[152:153], v48 offset:1792
    ds_read_b64_tr_b16 v[154:155], v48 offset:2016
    ds_read_b128 v[184:187], v127 offset:0
    ds_read_b64_tr_b16 v[156:157], v48 offset:2688
    ds_read_b64_tr_b16 v[158:159], v48 offset:2912
    s_add_u32 s80, s80, s76
    buffer_load_dwordx4 v47, s[32:35], s80 offen offset:3072 lds
    s_add_u32 s78, s78, s79
    s_bfe_u32 s74, s72, 262160
    s_mul_i32 s80, s74, s77
    s_mov_b32 m0, s78
    s_add_u32 s80, s80, s75
    buffer_load_dwordx4 v47, s[32:35], s80 offen offset:0 lds
    s_add_u32 s80, s80, s76
    buffer_load_dwordx4 v47, s[32:35], s80 offen offset:1024 lds
    s_add_u32 s80, s80, s76
    buffer_load_dwordx4 v47, s[32:35], s80 offen offset:2048 lds
    v_pk_fma_f32 v[120:121], v[68:69], v[68:69], v[120:121]
    v_pk_fma_f32 v[122:123], v[70:71], v[70:71], v[122:123]
    v_pk_fma_f32 v[120:121], v[72:73], v[72:73], v[120:121]
    v_pk_fma_f32 v[122:123], v[74:75], v[74:75], v[122:123]
    v_pk_fma_f32 v[120:121], v[76:77], v[76:77], v[120:121]
    v_pk_fma_f32 v[122:123], v[78:79], v[78:79], v[122:123]
    v_pk_fma_f32 v[120:121], v[80:81], v[80:81], v[120:121]
    v_pk_fma_f32 v[122:123], v[82:83], v[82:83], v[122:123]
    s_waitcnt lgkmcnt(9)
    v_mfma_f32_32x32x16_bf16 v[128:143], v[144:147], v[172:175], 0
    s_add_u32 s80, s80, s76
    buffer_load_dwordx4 v47, s[32:35], s80 offen offset:3072 lds
    s_waitcnt vmcnt(12)
    s_barrier
    ds_read_b128 v[188:191], v124 offset:4096
    ds_read_b64_tr_b16 v[160:161], v48 offset:4096
    ds_read_b64_tr_b16 v[162:163], v48 offset:4320
    v_fmac_f32 v120, v84, v84
    v_fmac_f32 v121, v85, v85
    v_fmac_f32 v122, v86, v86
    v_fmac_f32 v123, v87, v87
    s_waitcnt lgkmcnt(9)
    v_mfma_f32_32x32x16_bf16 v[128:143], v[148:151], v[176:179], v[128:143]
    s_add_u32 s78, s78, s79
    s_bfe_u32 s74, s72, 262164
    s_mul_i32 s80, s74, s77
    s_mov_b32 m0, s78
    s_add_u32 s80, s80, s75
    buffer_load_dwordx4 v47, s[32:35], s80 offen offset:0 lds
    ds_read_b128 v[172:175], v125 offset:4096
    ds_read_b64_tr_b16 v[144:145], v48 offset:4992
    ds_read_b64_tr_b16 v[146:147], v48 offset:5216
    v_fmac_f32 v120, v88, v88
    v_fmac_f32 v121, v89, v89
    v_fmac_f32 v122, v90, v90
    v_fmac_f32 v123, v91, v91
    s_waitcnt lgkmcnt(9)
    v_mfma_f32_32x32x16_bf16 v[128:143], v[152:155], v[180:183], v[128:143]
    s_add_u32 s80, s80, s76
    buffer_load_dwordx4 v47, s[32:35], s80 offen offset:1024 lds
    ds_read_b128 v[176:179], v126 offset:4096
    ds_read_b64_tr_b16 v[148:149], v48 offset:5888
    ds_read_b64_tr_b16 v[150:151], v48 offset:6112
    v_fmac_f32 v120, v92, v92
    v_fmac_f32 v121, v93, v93
    v_fmac_f32 v122, v94, v94
    v_fmac_f32 v123, v95, v95
    s_waitcnt lgkmcnt(9)
    v_mfma_f32_32x32x16_bf16 v[128:143], v[156:159], v[184:187], v[128:143]
    s_add_u32 s80, s80, s76
    buffer_load_dwordx4 v47, s[32:35], s80 offen offset:2048 lds
    ds_read_b128 v[180:183], v127 offset:4096
    ds_read_b64_tr_b16 v[152:153], v48 offset:6784
    ds_read_b64_tr_b16 v[154:155], v48 offset:7008
    v_fmac_f32 v120, v96, v96
    v_fmac_f32 v121, v97, v97
    v_fmac_f32 v122, v98, v98
    v_fmac_f32 v123, v99, v99
    s_waitcnt lgkmcnt(9)
    v_mfma_f32_32x32x16_bf16 v[128:143], v[160:163], v[188:191], v[128:143]
    s_add_u32 s80, s80, s76
    buffer_load_dwordx4 v47, s[32:35], s80 offen offset:3072 lds
    s_waitcnt vmcnt(8)
    s_barrier
    ds_read_b128 v[184:187], v124 offset:8192
    ds_read_b64_tr_b16 v[156:157], v48 offset:8192
    ds_read_b64_tr_b16 v[158:159], v48 offset:8416
    v_fmac_f32 v120, v100, v100
    v_fmac_f32 v121, v101, v101
    v_fmac_f32 v122, v102, v102
    v_fmac_f32 v123, v103, v103
    s_waitcnt lgkmcnt(9)
    v_mfma_f32_32x32x16_bf16 v[128:143], v[144:147], v[172:175], v[128:143]
    s_add_u32 s78, s78, s79
    s_bfe_u32 s74, s72, 262168
    s_mul_i32 s80, s74, s77
    s_mov_b32 m0, s78
    s_add_u32 s80, s80, s75
    buffer_load_dwordx4 v47, s[32:35], s80 offen offset:0 lds
    ds_read_b128 v[188:191], v125 offset:8192
    ds_read_b64_tr_b16 v[160:161], v48 offset:9088
    ds_read_b64_tr_b16 v[162:163], v48 offset:9312
    v_fmac_f32 v120, v104, v104
    v_fmac_f32 v121, v105, v105
    v_fmac_f32 v122, v106, v106
    v_fmac_f32 v123, v107, v107
    s_waitcnt lgkmcnt(9)
    v_mfma_f32_32x32x16_bf16 v[128:143], v[148:151], v[176:179], v[128:143]
    s_add_u32 s80, s80, s76
    buffer_load_dwordx4 v47, s[32:35], s80 offen offset:1024 lds
    ds_read_b128 v[172:175], v126 offset:8192
    ds_read_b64_tr_b16 v[144:145], v48 offset:9984
    ds_read_b64_tr_b16 v[146:147], v48 offset:10208
    v_fmac_f32 v120, v108, v108
    v_fmac_f32 v121, v109, v109
    v_fmac_f32 v122, v110, v110
    v_fmac_f32 v123, v111, v111
    s_waitcnt lgkmcnt(9)
    v_mfma_f32_32x32x16_bf16 v[128:143], v[152:155], v[180:183], v[128:143]
    s_add_u32 s80, s80, s76
    buffer_load_dwordx4 v47, s[32:35], s80 offen offset:2048 lds
    ds_read_b128 v[176:179], v127 offset:8192
    ds_read_b64_tr_b16 v[148:149], v48 offset:10880
    ds_read_b64_tr_b16 v[150:151], v48 offset:11104
    v_fmac_f32 v120, v112, v112
    v_fmac_f32 v121, v113, v113
    v_fmac_f32 v122, v114, v114
    v_fmac_f32 v123, v115, v115
    s_waitcnt lgkmcnt(9)
    v_mfma_f32_32x32x16_bf16 v[128:143], v[156:159], v[184:187], v[128:143]
    s_add_u32 s80, s80, s76
    buffer_load_dwordx4 v47, s[32:35], s80 offen offset:3072 lds
    ds_read_b128 v[180:183], v124 offset:12288
    ds_read_b64_tr_b16 v[152:153], v48 offset:12288
    ds_read_b64_tr_b16 v[154:155], v48 offset:12512
    v_fmac_f32 v120, v116, v116
    v_fmac_f32 v121, v117, v117
    v_fmac_f32 v122, v118, v118
    v_fmac_f32 v123, v119, v119
    s_waitcnt lgkmcnt(9)
    v_mfma_f32_32x32x16_bf16 v[128:143], v[160:163], v[188:191], v[128:143]
    ds_read_b128 v[184:187], v125 offset:12288
    ds_read_b64_tr_b16 v[156:157], v48 offset:13184
    ds_read_b64_tr_b16 v[158:159], v48 offset:13408
    v_add_f32 v120, v120, v121
    v_add_f32 v122, v122, v123
    v_add_f32 v120, v120, v122
    v_mov_b32 v121, 0x3727c5ac
    s_waitcnt lgkmcnt(9)
    v_mfma_f32_32x32x16_bf16 v[128:143], v[144:147], v[172:175], v[128:143]
    ds_read_b128 v[188:191], v126 offset:12288
    ds_read_b64_tr_b16 v[160:161], v48 offset:14080
    ds_read_b64_tr_b16 v[162:163], v48 offset:14304
    v_lshlrev_b32 v60, 2, v56
    v_add_f32_dpp v120, v120, v120 quad_perm:[1,0,3,2] row_mask:0xf bank_mask:0xf
    s_waitcnt lgkmcnt(9)
    v_mfma_f32_32x32x16_bf16 v[128:143], v[148:151], v[176:179], v[128:143]
    ds_read_b128 v[172:175], v127 offset:12288
    ds_read_b64_tr_b16 v[144:145], v48 offset:14976
    ds_read_b64_tr_b16 v[146:147], v48 offset:15200
    v_add_f32_dpp v120, v120, v120 quad_perm:[2,3,0,1] row_mask:0xf bank_mask:0xf
    s_waitcnt lgkmcnt(9)
    v_mfma_f32_32x32x16_bf16 v[128:143], v[152:155], v[180:183], v[128:143]
    s_waitcnt vmcnt(8)
    s_barrier
    ds_read_b128 v[176:179], v124 offset:16384
    ds_read_b64_tr_b16 v[148:149], v48 offset:16384
    ds_read_b64_tr_b16 v[150:151], v48 offset:16608
    v_add_f32_dpp v120, v120, v120 row_half_mirror row_mask:0xf bank_mask:0xf
    v_fmamk_f32 v120, v120, 0x3b124925, v121
    v_rsq_f32 v120, v120
    v_add_u32 v60, 163584, v60
    s_waitcnt lgkmcnt(9)
    v_mfma_f32_32x32x16_bf16 v[128:143], v[156:159], v[184:187], v[128:143]
    ds_read_b128 v[180:183], v125 offset:16384
    ds_read_b64_tr_b16 v[152:153], v48 offset:17280
    ds_read_b64_tr_b16 v[154:155], v48 offset:17504
    ds_write_b32 v59, v120
    s_waitcnt lgkmcnt(10)
    v_mfma_f32_32x32x16_bf16 v[128:143], v[160:163], v[188:191], v[128:143]
    ds_read_b128 v[184:187], v126 offset:16384
    ds_read_b64_tr_b16 v[156:157], v48 offset:18176
    ds_read_b64_tr_b16 v[158:159], v48 offset:18400
    s_waitcnt lgkmcnt(10)
    v_mfma_f32_32x32x16_bf16 v[128:143], v[144:147], v[172:175], v[128:143]
    ds_read_b128 v[188:191], v127 offset:16384
    ds_read_b64_tr_b16 v[160:161], v48 offset:19072
    ds_read_b64_tr_b16 v[162:163], v48 offset:19296
    s_waitcnt lgkmcnt(10)
    v_mfma_f32_32x32x16_bf16 v[128:143], v[148:151], v[176:179], v[128:143]
    s_waitcnt vmcnt(4) lgkmcnt(6)
    s_barrier
    ds_read_b128 v[172:175], v124 offset:20480
    ds_read_b64_tr_b16 v[144:145], v48 offset:20480
    ds_read_b64_tr_b16 v[146:147], v48 offset:20704
    v_mfma_f32_32x32x16_bf16 v[128:143], v[152:155], v[180:183], v[128:143]
    ds_read_b128 v[176:179], v125 offset:20480
    ds_read_b64_tr_b16 v[148:149], v48 offset:21376
    ds_read_b64_tr_b16 v[150:151], v48 offset:21600
    s_waitcnt lgkmcnt(9)
    v_mfma_f32_32x32x16_bf16 v[128:143], v[156:159], v[184:187], v[128:143]
    ds_read_b128 v[180:183], v126 offset:20480
    ds_read_b64_tr_b16 v[152:153], v48 offset:22272
    ds_read_b64_tr_b16 v[154:155], v48 offset:22496
    s_waitcnt lgkmcnt(9)
    v_mfma_f32_32x32x16_bf16 v[128:143], v[160:163], v[188:191], v[128:143]
    ds_read_b128 v[184:187], v127 offset:20480
    ds_read_b64_tr_b16 v[156:157], v48 offset:23168
    ds_read_b64_tr_b16 v[158:159], v48 offset:23392
    s_waitcnt lgkmcnt(9)
    v_mfma_f32_32x32x16_bf16 v[128:143], v[144:147], v[172:175], v[128:143]
    s_waitcnt vmcnt(0)
    s_barrier
    ds_read_b128 v[188:191], v124 offset:24576
    ds_read_b64_tr_b16 v[160:161], v48 offset:24576
    ds_read_b64_tr_b16 v[162:163], v48 offset:24800
    s_waitcnt lgkmcnt(9)
    v_mfma_f32_32x32x16_bf16 v[128:143], v[148:151], v[176:179], v[128:143]
    ds_read_b128 v[172:175], v125 offset:24576
    ds_read_b64_tr_b16 v[144:145], v48 offset:25472
    ds_read_b64_tr_b16 v[146:147], v48 offset:25696
    s_waitcnt lgkmcnt(9)
    v_mfma_f32_32x32x16_bf16 v[128:143], v[152:155], v[180:183], v[128:143]
    ds_read_b128 v[176:179], v126 offset:24576
    ds_read_b64_tr_b16 v[148:149], v48 offset:26368
    ds_read_b64_tr_b16 v[150:151], v48 offset:26592
    s_waitcnt lgkmcnt(9)
    v_mfma_f32_32x32x16_bf16 v[128:143], v[156:159], v[184:187], v[128:143]
    ds_read_b128 v[180:183], v127 offset:24576
    ds_read_b64_tr_b16 v[152:153], v48 offset:27264
    ds_read_b64_tr_b16 v[154:155], v48 offset:27488
    s_waitcnt lgkmcnt(9)
    v_mfma_f32_32x32x16_bf16 v[128:143], v[160:163], v[188:191], v[128:143]
    ds_read_b32 v196, v60
    s_waitcnt lgkmcnt(7)
    v_mfma_f32_32x32x16_bf16 v[128:143], v[144:147], v[172:175], v[128:143]
    s_waitcnt lgkmcnt(4)
    v_mfma_f32_32x32x16_bf16 v[128:143], v[148:151], v[176:179], v[128:143]
    s_waitcnt lgkmcnt(1)
    v_mfma_f32_32x32x16_bf16 v[128:143], v[152:155], v[180:183], v[128:143]
    s_waitcnt lgkmcnt(0)
    v_mul_f32 v196, 0x3e8b97f6, v196
    v_cmp_lt_u32 vcc, 31, v0
    v_mov_b32 v57, 0x3f803f80
    v_mov_b32 v58, 0x00003f80
    s_nop 6
    v_pk_mul_f32 v[128:129], v[128:129], v[196:197] op_sel_hi:[1,0]
    v_pk_mul_f32 v[130:131], v[130:131], v[196:197] op_sel_hi:[1,0]
    v_pk_mul_f32 v[132:133], v[132:133], v[196:197] op_sel_hi:[1,0]
    v_pk_mul_f32 v[134:135], v[134:135], v[196:197] op_sel_hi:[1,0]
    v_cvt_pk_bf16_f32 v144, v128, v129
    v_cvt_pk_bf16_f32 v145, v130, v131
    v_cvt_pk_bf16_f32 v146, v132, v133
    v_cvt_pk_bf16_f32 v147, v134, v135
    buffer_store_dwordx4 v[144:147], v1, s[24:27], s73 offen offset:0 sc1
    v_pk_mul_f32 v[136:137], v[136:137], v[196:197] op_sel_hi:[1,0]
    v_pk_mul_f32 v[138:139], v[138:139], v[196:197] op_sel_hi:[1,0]
    v_pk_mul_f32 v[140:141], v[140:141], v[196:197] op_sel_hi:[1,0]
    v_pk_mul_f32 v[142:143], v[142:143], v[196:197] op_sel_hi:[1,0]
    v_cvt_pk_bf16_f32 v148, v136, v137
    v_cvt_pk_bf16_f32 v149, v138, v139
    v_cvt_pk_bf16_f32 v150, v140, v141
    v_cvt_pk_bf16_f32 v151, v142, v143
    v_cndmask_b32 v150, v150, v57, vcc
    v_cndmask_b32 v151, v151, v58, vcc
    buffer_store_dwordx4 v[148:151], v1, s[24:27], s73 offen offset:1024 sc1
    s_branch L_g_end_3
L_g_v_2:
    s_waitcnt vmcnt(11)
    s_barrier
    ds_read_b128 v[172:175], v124 offset:0
    ds_read_b64_tr_b16 v[144:145], v48 offset:0
    ds_read_b64_tr_b16 v[146:147], v48 offset:224
    ds_read_b128 v[176:179], v125 offset:0
    ds_read_b64_tr_b16 v[148:149], v48 offset:896
    ds_read_b64_tr_b16 v[150:151], v48 offset:1120
    ds_read_b128 v[180:183], v126 offset:0
    ds_read_b64_tr_b16 v[152:153], v48 offset:1792
    ds_read_b64_tr_b16 v[154:155], v48 offset:2016
    ds_read_b128 v[184:187], v127 offset:0
    ds_read_b64_tr_b16 v[156:157], v48 offset:2688
    ds_read_b64_tr_b16 v[158:159], v48 offset:2912
    s_add_u32 s80, s80, s76
    buffer_load_dwordx4 v47, s[32:35], s80 offen offset:3072 lds
    s_add_u32 s78, s78, s79
    s_bfe_u32 s74, s72, 262160
    s_mul_i32 s80, s74, s77
    s_mov_b32 m0, s78
    s_add_u32 s80, s80, s75
    buffer_load_dwordx4 v47, s[32:35], s80 offen offset:0 lds
    s_add_u32 s80, s80, s76
    buffer_load_dwordx4 v47, s[32:35], s80 offen offset:1024 lds
    s_add_u32 s80, s80, s76
    buffer_load_dwordx4 v47, s[32:35], s80 offen offset:2048 lds
    v_pk_fma_f32 v[120:121], v[68:69], v[68:69], v[120:121]
    v_pk_fma_f32 v[122:123], v[70:71], v[70:71], v[122:123]
    v_pk_fma_f32 v[120:121], v[72:73], v[72:73], v[120:121]
    v_pk_fma_f32 v[122:123], v[74:75], v[74:75], v[122:123]
    v_pk_fma_f32 v[120:121], v[76:77], v[76:77], v[120:121]
    v_pk_fma_f32 v[122:123], v[78:79], v[78:79], v[122:123]
    v_pk_fma_f32 v[120:121], v[80:81], v[80:81], v[120:121]
    v_pk_fma_f32 v[122:123], v[82:83], v[82:83], v[122:123]
    s_waitcnt lgkmcnt(9)
    v_mfma_f32_32x32x16_bf16 v[128:143], v[172:175], v[144:147], 0
    s_add_u32 s80, s80, s76
    buffer_load_dwordx4 v47, s[32:35], s80 offen offset:3072 lds
    s_waitcnt vmcnt(12)
    s_barrier
    ds_read_b128 v[188:191], v124 offset:4096
    ds_read_b64_tr_b16 v[160:161], v48 offset:4096
    ds_read_b64_tr_b16 v[162:163], v48 offset:4320
    v_fmac_f32 v120, v84, v84
    v_fmac_f32 v121, v85, v85
    v_fmac_f32 v122, v86, v86
    v_fmac_f32 v123, v87, v87
    s_waitcnt lgkmcnt(9)
    v_mfma_f32_32x32x16_bf16 v[128:143], v[176:179], v[148:151], v[128:143]
    s_add_u32 s78, s78, s79
    s_bfe_u32 s74, s72, 262164
    s_mul_i32 s80, s74, s77
    s_mov_b32 m0, s78
    s_add_u32 s80, s80, s75
    buffer_load_dwordx4 v47, s[32:35], s80 offen offset:0 lds
    ds_read_b128 v[172:175], v125 offset:4096
    ds_read_b64_tr_b16 v[144:145], v48 offset:4992
    ds_read_b64_tr_b16 v[146:147], v48 offset:5216
    v_fmac_f32 v120, v88, v88
    v_fmac_f32 v121, v89, v89
    v_fmac_f32 v122, v90, v90
    v_fmac_f32 v123, v91, v91
    s_waitcnt lgkmcnt(9)
    v_mfma_f32_32x32x16_bf16 v[128:143], v[180:183], v[152:155], v[128:143]
    s_add_u32 s80, s80, s76
    buffer_load_dwordx4 v47, s[32:35], s80 offen offset:1024 lds
    ds_read_b128 v[176:179], v126 offset:4096
    ds_read_b64_tr_b16 v[148:149], v48 offset:5888
    ds_read_b64_tr_b16 v[150:151], v48 offset:6112
    v_fmac_f32 v120, v92, v92
    v_fmac_f32 v121, v93, v93
    v_fmac_f32 v122, v94, v94
    v_fmac_f32 v123, v95, v95
    s_waitcnt lgkmcnt(9)
    v_mfma_f32_32x32x16_bf16 v[128:143], v[184:187], v[156:159], v[128:143]
    s_add_u32 s80, s80, s76
    buffer_load_dwordx4 v47, s[32:35], s80 offen offset:2048 lds
    ds_read_b128 v[180:183], v127 offset:4096
    ds_read_b64_tr_b16 v[152:153], v48 offset:6784
    ds_read_b64_tr_b16 v[154:155], v48 offset:7008
    v_fmac_f32 v120, v96, v96
    v_fmac_f32 v121, v97, v97
    v_fmac_f32 v122, v98, v98
    v_fmac_f32 v123, v99, v99
    s_waitcnt lgkmcnt(9)
    v_mfma_f32_32x32x16_bf16 v[128:143], v[188:191], v[160:163], v[128:143]
    s_add_u32 s80, s80, s76
    buffer_load_dwordx4 v47, s[32:35], s80 offen offset:3072 lds
    s_waitcnt vmcnt(8)
    s_barrier
    ds_read_b128 v[184:187], v124 offset:8192
    ds_read_b64_tr_b16 v[156:157], v48 offset:8192
    ds_read_b64_tr_b16 v[158:159], v48 offset:8416
    v_fmac_f32 v120, v100, v100
    v_fmac_f32 v121, v101, v101
    v_fmac_f32 v122, v102, v102
    v_fmac_f32 v123, v103, v103
    s_waitcnt lgkmcnt(9)
    v_mfma_f32_32x32x16_bf16 v[128:143], v[172:175], v[144:147], v[128:143]
    s_add_u32 s78, s78, s79
    s_bfe_u32 s74, s72, 262168
    s_mul_i32 s80, s74, s77
    s_mov_b32 m0, s78
    s_add_u32 s80, s80, s75
    buffer_load_dwordx4 v47, s[32:35], s80 offen offset:0 lds
    ds_read_b128 v[188:191], v125 offset:8192
    ds_read_b64_tr_b16 v[160:161], v48 offset:9088
    ds_read_b64_tr_b16 v[162:163], v48 offset:9312
    v_fmac_f32 v120, v104, v104
    v_fmac_f32 v121, v105, v105
    v_fmac_f32 v122, v106, v106
    v_fmac_f32 v123, v107, v107
    s_waitcnt lgkmcnt(9)
    v_mfma_f32_32x32x16_bf16 v[128:143], v[176:179], v[148:151], v[128:143]
    s_add_u32 s80, s80, s76
    buffer_load_dwordx4 v47, s[32:35], s80 offen offset:1024 lds
    ds_read_b128 v[172:175], v126 offset:8192
    ds_read_b64_tr_b16 v[144:145], v48 offset:9984
    ds_read_b64_tr_b16 v[146:147], v48 offset:10208
    v_fmac_f32 v120, v108, v108
    v_fmac_f32 v121, v109, v109
    v_fmac_f32 v122, v110, v110
    v_fmac_f32 v123, v111, v111
    s_waitcnt lgkmcnt(9)
    v_mfma_f32_32x32x16_bf16 v[128:143], v[180:183], v[152:155], v[128:143]
    s_add_u32 s80, s80, s76
    buffer_load_dwordx4 v47, s[32:35], s80 offen offset:2048 lds
    ds_read_b128 v[176:179], v127 offset:8192
    ds_read_b64_tr_b16 v[148:149], v48 offset:10880
    ds_read_b64_tr_b16 v[150:151], v48 offset:11104
    v_fmac_f32 v120, v112, v112
    v_fmac_f32 v121, v113, v113
    v_fmac_f32 v122, v114, v114
    v_fmac_f32 v123, v115, v115
    s_waitcnt lgkmcnt(9)
    v_mfma_f32_32x32x16_bf16 v[128:143], v[184:187], v[156:159], v[128:143]
    s_add_u32 s80, s80, s76
    buffer_load_dwordx4 v47, s[32:35], s80 offen offset:3072 lds
    ds_read_b128 v[180:183], v124 offset:12288
    ds_read_b64_tr_b16 v[152:153], v48 offset:12288
    ds_read_b64_tr_b16 v[154:155], v48 offset:12512
    v_fmac_f32 v120, v116, v116
    v_fmac_f32 v121, v117, v117
    v_fmac_f32 v122, v118, v118
    v_fmac_f32 v123, v119, v119
    s_waitcnt lgkmcnt(9)
    v_mfma_f32_32x32x16_bf16 v[128:143], v[188:191], v[160:163], v[128:143]
    ds_read_b128 v[184:187], v125 offset:12288
    ds_read_b64_tr_b16 v[156:157], v48 offset:13184
    ds_read_b64_tr_b16 v[158:159], v48 offset:13408
    v_add_f32 v120, v120, v121
    v_add_f32 v122, v122, v123
    v_add_f32 v120, v120, v122
    v_mov_b32 v121, 0x3727c5ac
    s_waitcnt lgkmcnt(9)
    v_mfma_f32_32x32x16_bf16 v[128:143], v[172:175], v[144:147], v[128:143]
    ds_read_b128 v[188:191], v126 offset:12288
    ds_read_b64_tr_b16 v[160:161], v48 offset:14080
    ds_read_b64_tr_b16 v[162:163], v48 offset:14304
    v_lshlrev_b32 v60, 5, v51
    v_add_f32_dpp v120, v120, v120 quad_perm:[1,0,3,2] row_mask:0xf bank_mask:0xf
    s_waitcnt lgkmcnt(9)
    v_mfma_f32_32x32x16_bf16 v[128:143], v[176:179], v[148:151], v[128:143]
    ds_read_b128 v[172:175], v127 offset:12288
    ds_read_b64_tr_b16 v[144:145], v48 offset:14976
    ds_read_b64_tr_b16 v[146:147], v48 offset:15200
    v_add_f32_dpp v120, v120, v120 quad_perm:[2,3,0,1] row_mask:0xf bank_mask:0xf
    s_waitcnt lgkmcnt(9)
    v_mfma_f32_32x32x16_bf16 v[128:143], v[180:183], v[152:155], v[128:143]
    s_waitcnt vmcnt(8)
    s_barrier
    ds_read_b128 v[176:179], v124 offset:16384
    ds_read_b64_tr_b16 v[148:149], v48 offset:16384
    ds_read_b64_tr_b16 v[150:151], v48 offset:16608
    v_add_f32_dpp v120, v120, v120 row_half_mirror row_mask:0xf bank_mask:0xf
    v_fmamk_f32 v120, v120, 0x3b124925, v121
    v_rsq_f32 v120, v120
    v_add_u32 v60, 163584, v60
    s_waitcnt lgkmcnt(9)
    v_mfma_f32_32x32x16_bf16 v[128:143], v[184:187], v[156:159], v[128:143]
    ds_read_b128 v[180:183], v125 offset:16384
    ds_read_b64_tr_b16 v[152:153], v48 offset:17280
    ds_read_b64_tr_b16 v[154:155], v48 offset:17504
    ds_write_b32 v59, v120
    s_waitcnt lgkmcnt(10)
    v_mfma_f32_32x32x16_bf16 v[128:143], v[188:191], v[160:163], v[128:143]
    ds_read_b128 v[184:187], v126 offset:16384
    ds_read_b64_tr_b16 v[156:157], v48 offset:18176
    ds_read_b64_tr_b16 v[158:159], v48 offset:18400
    s_waitcnt lgkmcnt(10)
    v_mfma_f32_32x32x16_bf16 v[128:143], v[172:175], v[144:147], v[128:143]
    ds_read_b128 v[188:191], v127 offset:16384
    ds_read_b64_tr_b16 v[160:161], v48 offset:19072
    ds_read_b64_tr_b16 v[162:163], v48 offset:19296
    s_waitcnt lgkmcnt(10)
    v_mfma_f32_32x32x16_bf16 v[128:143], v[176:179], v[148:151], v[128:143]
    s_waitcnt vmcnt(4) lgkmcnt(6)
    s_barrier
    ds_read_b128 v[172:175], v124 offset:20480
    ds_read_b64_tr_b16 v[144:145], v48 offset:20480
    ds_read_b64_tr_b16 v[146:147], v48 offset:20704
    v_mfma_f32_32x32x16_bf16 v[128:143], v[180:183], v[152:155], v[128:143]
    ds_read_b128 v[176:179], v125 offset:20480
    ds_read_b64_tr_b16 v[148:149], v48 offset:21376
    ds_read_b64_tr_b16 v[150:151], v48 offset:21600
    s_waitcnt lgkmcnt(9)
    v_mfma_f32_32x32x16_bf16 v[128:143], v[184:187], v[156:159], v[128:143]
    ds_read_b128 v[180:183], v126 offset:20480
    ds_read_b64_tr_b16 v[152:153], v48 offset:22272
    ds_read_b64_tr_b16 v[154:155], v48 offset:22496
    s_waitcnt lgkmcnt(9)
    v_mfma_f32_32x32x16_bf16 v[128:143], v[188:191], v[160:163], v[128:143]
    ds_read_b128 v[184:187], v127 offset:20480
    ds_read_b64_tr_b16 v[156:157], v48 offset:23168
    ds_read_b64_tr_b16 v[158:159], v48 offset:23392
    s_waitcnt lgkmcnt(9)
    v_mfma_f32_32x32x16_bf16 v[128:143], v[172:175], v[144:147], v[128:143]
    s_waitcnt vmcnt(0)
    s_barrier
    ds_read_b128 v[188:191], v124 offset:24576
    ds_read_b64_tr_b16 v[160:161], v48 offset:24576
    ds_read_b64_tr_b16 v[162:163], v48 offset:24800
    s_waitcnt lgkmcnt(9)
    v_mfma_f32_32x32x16_bf16 v[128:143], v[176:179], v[148:151], v[128:143]
    ds_read_b128 v[172:175], v125 offset:24576
    ds_read_b64_tr_b16 v[144:145], v48 offset:25472
    ds_read_b64_tr_b16 v[146:147], v48 offset:25696
    s_waitcnt lgkmcnt(9)
    v_mfma_f32_32x32x16_bf16 v[128:143], v[180:183], v[152:155], v[128:143]
    ds_read_b128 v[176:179], v126 offset:24576
    ds_read_b64_tr_b16 v[148:149], v48 offset:26368
    ds_read_b64_tr_b16 v[150:151], v48 offset:26592
    s_waitcnt lgkmcnt(9)
    v_mfma_f32_32x32x16_bf16 v[128:143], v[184:187], v[156:159], v[128:143]
    ds_read_b128 v[180:183], v127 offset:24576
    ds_read_b64_tr_b16 v[152:153], v48 offset:27264
    ds_read_b64_tr_b16 v[154:155], v48 offset:27488
    s_waitcnt lgkmcnt(9)
    v_mfma_f32_32x32x16_bf16 v[128:143], v[188:191], v[160:163], v[128:143]
    ds_read_b128 v[196:199], v60 offset:0
    ds_read_b128 v[200:203], v60 offset:16
    ds_read_b128 v[204:207], v60 offset:64
    ds_read_b128 v[208:211], v60 offset:80
    s_waitcnt lgkmcnt(10)
    v_mfma_f32_32x32x16_bf16 v[128:143], v[172:175], v[144:147], v[128:143]
    s_waitcnt lgkmcnt(7)
    v_mfma_f32_32x32x16_bf16 v[128:143], v[176:179], v[148:151], v[128:143]
    s_waitcnt lgkmcnt(4)
    v_mfma_f32_32x32x16_bf16 v[128:143], v[180:183], v[152:155], v[128:143]
    s_waitcnt lgkmcnt(0)
    v_cmp_eq_u32 vcc, 28, v56
    v_mov_b32 v57, 0x3f803f80
    s_nop 0
    v_cndmask_b32 v57, 0, v57, vcc
    v_cmp_lt_u32 vcc, 27, v56
    s_nop 5
    v_pk_mul_f32 v[128:129], v[128:129], v[196:197]
    v_pk_mul_f32 v[130:131], v[130:131], v[198:199]
    v_pk_mul_f32 v[132:133], v[132:133], v[200:201]
    v_pk_mul_f32 v[134:135], v[134:135], v[202:203]
    v_cvt_pk_bf16_f32 v144, v128, v129
    v_cvt_pk_bf16_f32 v145, v130, v131
    v_cvt_pk_bf16_f32 v146, v132, v133
    v_cvt_pk_bf16_f32 v147, v134, v135
    v_cndmask_b32 v144, v144, v57, vcc
    v_cndmask_b32 v145, v145, v57, vcc
    v_cndmask_b32 v146, v146, v57, vcc
    v_cndmask_b32 v147, v147, v57, vcc
    buffer_store_dwordx4 v[144:147], v1, s[24:27], s73 offen offset:2048 sc1
    v_pk_mul_f32 v[136:137], v[136:137], v[204:205]
    v_pk_mul_f32 v[138:139], v[138:139], v[206:207]
    v_pk_mul_f32 v[140:141], v[140:141], v[208:209]
    v_pk_mul_f32 v[142:143], v[142:143], v[210:211]
    v_cvt_pk_bf16_f32 v148, v136, v137
    v_cvt_pk_bf16_f32 v149, v138, v139
    v_cvt_pk_bf16_f32 v150, v140, v141
    v_cvt_pk_bf16_f32 v151, v142, v143
    v_cndmask_b32 v148, v148, v57, vcc
    v_cndmask_b32 v149, v149, v57, vcc
    v_cndmask_b32 v150, v150, v57, vcc
    v_cndmask_b32 v151, v151, v57, vcc
    buffer_store_dwordx4 v[148:151], v1, s[24:27], s73 offen offset:3072 sc1
L_g_end_3:
    v_and_b32 v58, 15, v0
    v_cmp_lt_u32 vcc, 15, v0
    s_add_u32 s81, s83, 3072
    v_lshl_add_u32 v57, v56, 2, s81
    s_mul_i32 s81, s70, 28
    s_mul_i32 s82, s61, 7
    s_add_u32 s81, s81, s82
    s_lshr_b32 s82, s90, 1
    s_min_u32 s82, s82, 6
    s_mul_i32 s8, s82, 57344
    s_mul_i32 s82, s82, 7
    s_add_u32 s82, s82, 196
    v_mov_b32 v231, s81
    v_mov_b32 v54, s82
    v_cndmask_b32 v231, v231, v54, vcc
    v_min_u32 v54, 6, v58
    v_cmp_lt_u32 vcc, 31, v0
    v_add_u32 v231, v231, v54
    v_lshlrev_b32 v231, 7, v231
    v_add_u32 v231, 36864, v231
    v_cndmask_b32 v231, v231, v57, vcc
    s_lshl_b32 s21, s81, 13
    s_add_u32 s21, s21, 6291456
    s_and_b32 s81, s61, 1
    s_lshl_b32 s81, s81, 10
    s_add_u32 s8, s8, s81
    s_add_u32 s8, s8, 7897088
    s_lshl_b32 s81, s71, 7
    s_mul_i32 s82, s61, 28
    s_add_u32 s81, s81, s82
    s_add_u32 s81, s81, s83
    s_add_u32 s81, s81, 1024
    v_min_u32 v12, 6, v0
    v_lshl_add_u32 v12, v12, 2, s81
    v_and_b32 v58, 15, v0
    s_mul_i32 s13, s62, 28672
    s_mul_i32 s81, s61, 7168
    s_add_u32 s11, s13, s81
    s_add_u32 s11, s11, 2097152
    s_lshr_b32 s82, s61, 1
    s_lshl_b32 s82, s82, 7
    s_mul_i32 s81, s61, 12288
    s_add_u32 s12, s81, s82
    s_add_u32 s12, s12, 114688
    s_min_u32 s82, s90, 13
    s_lshl_b32 s81, s82, 11
    s_add_u32 s14, s13, s81
    s_add_u32 s14, s14, 2097152
    s_lshl_b32 s81, s82, 6
    s_add_u32 s13, s13, s81
    v_mul_u32_u24 v248, 896, v56
    v_lshl_add_u32 v248, v51, 4, v248
    s_lshl_b32 s15, s62, 10
    s_add_u32 s15, s15, 262144
    v_min_u32 v57, 13, v58
    v_lshl_add_u32 v232, v57, 7, s9
    v_cmp_lt_u32 vcc, 15, v0
    v_lshl_add_u32 v54, v45, 7, s15
    s_lshl_b32 s81, s61, 10
    v_cndmask_b32 v232, v232, v54, vcc
    s_add_u32 s81, s81, s83
    v_cmp_lt_u32 vcc, 23, v0
    v_lshl_add_u32 v54, v45, 7, s81
    s_lshl_b32 s81, s63, 2
    v_cndmask_b32 v232, v232, v54, vcc
    s_add_u32 s15, s15, s81
    s_sub_u32 s81, s5, s81
    v_lshl_add_u32 v252, v50, 2, s81
    s_lshl_b32 s81, s64, 3
    s_add_u32 s82, s81, s61
    s_mul_i32 s17, s82, 28672
    s_add_u32 s17, s17, 2097152
    s_lshl_b32 s18, s82, 10
    s_add_u32 s18, s18, 262144
    s_mul_i32 s19, s82, 28
    s_add_u32 s19, s19, s65
    s_lshl_b32 s19, s19, 12
    s_add_u32 s19, s19, 8388608
    s_add_u32 s81, s81, s71
    s_mul_i32 s23, s81, 28672
    s_lshl_b32 s81, s81, 2
    s_add_u32 s81, s81, s61
    s_mul_i32 s22, s81, 28672
    s_add_u32 s22, s22, 8388608
    s_mul_i32 s82, s61, 1152
    s_and_b32 s82, s82, 1280
    v_xor_b32 v6, s82, v1
    v_xor_b32 v7, 1024, v6
    s_add_u32 s74, s67, 1
    s_xor_b32 s74, s74, s66
    v_mov_b32 v4, s66
    v_mov_b32 v253, s74
    s_mov_b32 s32, s24
    s_mov_b32 s33, s25
    s_cmp_eq_u32 s61, 1
    s_cselect_b32 s34, 15728640, 0
    s_lshl_b32 s72, s61, 11
    s_add_u32 m0, s72, 114688
    s_waitcnt vmcnt(0)
    s_barrier
    buffer_store_dword v253, v2, s[32:35], s5 offen
    s_mov_b32 s91, 0
    s_mov_b64 exec, 0
    s_cmp_eq_u32 s61, 0
    s_cbranch_scc1 L_hop_in0
    s_cmp_eq_u32 s61, 1
    s_cbranch_scc1 L_hop_in1
    s_cmp_eq_u32 s61, 2
    s_cbranch_scc1 L_hop_in2
    s_branch L_hop_in3
L_hop_out:
    s_mov_b64 exec, -1
    buffer_load_dword v224, v228, s[24:27], 0 offen sc1
    buffer_store_dwordx2 v[4:5], v2, s[52:55], s4 offen sc1
    s_waitcnt vmcnt(1)
    s_branch L_x1test_5
L_x1loc_4:
    buffer_load_dword v224, v228, s[24:27], 0 offen sc1
    s_waitcnt vmcnt(0)
L_x1test_5:
    v_cmp_ne_u32 vcc, s74, v224
    s_add_u32 s91, s91, 1
    s_cbranch_vccz L_x1_ok
    s_cmp_lt_u32 s91, 12
    s_cbranch_scc1 L_x1loc_4
    s_mov_b32 s91, 0
L_x1_6:
    s_sleep 2
    buffer_load_dword v224, v230, s[24:27], 0 offen offset:0 sc1
    s_waitcnt vmcnt(0)
    v_cmp_ne_u32 vcc, s66, v224
    s_add_u32 s91, s91, 1
    s_cbranch_vccz L_x1_ok_7
    s_cmp_lt_u32 s91, 400000
    s_cbranch_scc1 L_x1_6
L_x1_ok_7:
L_x1_ok:
    buffer_load_dwordx4 v1, s[24:27], s6 offen sc1 lds
    buffer_load_dwordx4 v1, s[24:27], s6 offen offset:1024 sc1 lds
    buffer_load_dwordx4 v[160:163], v1, s[24:27], s7 offen offset:0 sc1
    buffer_load_dwordx4 v[164:167], v1, s[24:27], s7 offen offset:1024 sc1
    v_mov_b64 v[80:81], 0
    v_mov_b64 v[82:83], 0
    v_mov_b64 v[84:85], 0
    v_mov_b64 v[86:87], 0
    v_mov_b64 v[88:89], 0
    v_mov_b64 v[90:91], 0
    v_mov_b64 v[92:93], 0
    v_mov_b64 v[94:95], 0
    v_mov_b64 v[96:97], 0
    v_mov_b64 v[98:99], 0
    v_mov_b64 v[100:101], 0
    v_mov_b64 v[102:103], 0
    v_mov_b64 v[104:105], 0
    v_mov_b64 v[106:107], 0
    v_mov_b64 v[108:109], 0
    v_mov_b64 v[110:111], 0
    buffer_load_dwordx4 v[168:171], v1, s[24:27], s7 offen offset:2048 sc1
    buffer_load_dwordx4 v[172:175], v1, s[24:27], s7 offen offset:3072 sc1
    v_bfe_u32 v57, v0, 3, 2
    v_mad_u32_u24 v54, v57, 7, v51
    v_lshrrev_b32 v244, 1, v54
    v_lshlrev_b32 v244, 7, v244
    v_and_b32 v54, 1, v54
    v_lshl_add_u32 v244, v54, 3, v244
    v_lshl_add_u32 v244, v45, 4, v244
    s_add_u32 s81, s61, 1
    s_and_b32 s81, s81, 3
    s_mul_i32 s82, s81, 1792
    s_add_u32 s82, s82, 114688
    v_add_u32 v236, s82, v244
    s_mul_i32 s81, s81, 12288
    s_add_u32 s81, s81, 114688
    v_add_u32 v240, s81, v1
    s_add_u32 s81, s61, 2
    s_and_b32 s81, s81, 3
    s_mul_i32 s82, s81, 1792
    s_add_u32 s82, s82, 114688
    v_add_u32 v237, s82, v244
    s_mul_i32 s81, s81, 12288
    s_add_u32 s81, s81, 118784
    v_add_u32 v241, s81, v1
    s_add_u32 s81, s61, 3
    s_and_b32 s81, s81, 3
    s_mul_i32 s82, s81, 1792
    s_add_u32 s82, s82, 114688
    v_add_u32 v238, s82, v244
    s_mul_i32 s81, s81, 12288
    s_add_u32 s81, s81, 122880
    v_add_u32 v242, s81, v1
    s_add_u32 s81, s61, 4
    s_and_b32 s81, s81, 3
    s_mul_i32 s82, s81, 1792
    s_add_u32 s82, s82, 114688
    v_add_u32 v239, s82, v244
    s_mul_i32 s81, s81, 12288
    s_add_u32 s81, s81, 114688
    v_add_u32 v243, s81, v1
    v_mul_u32_u24 v245, 12288, v50
    v_add_u32 v245, 126720, v245
    v_mul_u32_u24 v247, 12288, v57
    v_add_u32 v54, v52, v51
    v_lshl_add_u32 v247, v54, 7, v247
    v_lshl_add_u32 v247, v45, 4, v247
    v_add_u32 v247, 114688, v247
    v_add_u32 v251, 160768, v1
    s_lshl_b32 s81, s61, 2
    v_add_u32 v250, s81, v251
    buffer_load_dwordx4 v[176:179], v3, s[24:27], s7 offen offset:0 sc1
    buffer_load_dwordx4 v[180:183], v3, s[24:27], s7 offen offset:1024 sc1
    buffer_load_dwordx4 v[184:187], v3, s[24:27], s7 offen offset:2048 sc1
    buffer_load_dwordx4 v[188:191], v3, s[24:27], s7 offen offset:3072 sc1
    s_add_u32 s7, s7, 32768
    s_and_b32 s7, s7, 786431
    s_bfe_u32 s76, s100, 262144
    s_lshl_b32 s76, s76, 12
    s_bfe_u32 s77, s100, 262148
    s_lshl_b32 s77, s77, 12
    s_bfe_u32 s78, s100, 262152
    s_lshl_b32 s78, s78, 12
    s_bfe_u32 s79, s100, 262156
    s_lshl_b32 s79, s79, 12
    s_bfe_u32 s80, s100, 262160
    s_lshl_b32 s80, s80, 12
    s_bfe_u32 s81, s100, 262164
    s_lshl_b32 s81, s81, 12
    s_bfe_u32 s82, s100, 262168
    s_lshl_b32 s82, s82, 12
    v_mov_b64 v[22:23], 0
    v_mov_b64 v[30:31], 0
    v_mov_b64 v[38:39], 0
    v_mov_b64 v[46:47], 0
    v_mov_b64 v[48:49], 0
    v_mov_b64 v[50:51], 0
    v_mov_b64 v[52:53], 0
    v_mov_b64 v[54:55], 0
    v_mov_b64 v[56:57], 0
    v_mov_b64 v[58:59], 0
    v_mov_b64 v[60:61], 0
    v_mov_b64 v[62:63], 0
    v_mov_b64 v[64:65], 0
    v_mov_b64 v[66:67], 0
    v_mov_b64 v[68:69], 0
    v_mov_b64 v[70:71], 0
    v_mov_b64 v[72:73], 0
    v_mov_b64 v[74:75], 0
    v_mov_b64 v[76:77], 0
    v_mov_b64 v[78:79], 0
    v_mov_b32 v5, 0xdddd
    s_mov_b32 exec_hi, 0
    v_mov_b32 v253, s66
    s_mov_b32 exec_hi, -1
    s_cmp_lt_u32 s90, 14
    s_cselect_b32 s34, 15728640, 0
    s_waitcnt vmcnt(8)
    s_barrier
    s_mov_b32 exec_hi, 0
    ds_read_b64 v[22:23], v236 offset:384
    ds_read_b64 v[30:31], v237 offset:384
    ds_read_b64 v[38:39], v238 offset:384
    ds_read_b64 v[46:47], v239 offset:384
    s_mov_b32 exec_hi, -1
    ds_read_b64 v[16:17], v236 offset:0
    ds_read_b64 v[18:19], v236 offset:128
    ds_read_b64 v[20:21], v236 offset:256
    ds_read_b64 v[24:25], v237 offset:0
    ds_read_b64 v[26:27], v237 offset:128
    ds_read_b64 v[28:29], v237 offset:256
    ds_read_b64 v[32:33], v238 offset:0
    ds_read_b64 v[34:35], v238 offset:128
    ds_read_b64 v[36:37], v238 offset:256
    ds_read_b64 v[40:41], v239 offset:0
    ds_read_b64 v[42:43], v239 offset:128
    ds_read_b64 v[44:45], v239 offset:256
L_attn_main:
    s_waitcnt vmcnt(6) lgkmcnt(9)
    v_mfma_f32_32x32x16_bf16 v[112:127], v[160:163], v[16:19], 0
    v_mfma_f32_32x32x16_bf16 v[112:127], v[164:167], v[20:23], v[112:127]
    s_waitcnt lgkmcnt(0)
    s_nop 9
    v_mfma_f32_32x32x16_bf16 v[128:143], v[160:163], v[24:27], 0
    buffer_load_dword v224, v229, s[24:27], 0 offen sc1
    v_exp_f32 v112, v112
    v_exp_f32 v113, v113
    v_exp_f32 v114, v114
    v_exp_f32 v115, v115
    v_mfma_f32_32x32x16_bf16 v[128:143], v[164:167], v[28:31], v[128:143]
    s_waitcnt vmcnt(5)
    v_exp_f32 v116, v116
    v_exp_f32 v117, v117
    v_exp_f32 v118, v118
    v_exp_f32 v119, v119
    buffer_load_dword v225, v230, s[24:27], 0 offen sc1
    s_mov_b32 m0, s97
    v_exp_f32 v120, v120
    v_exp_f32 v121, v121
    v_exp_f32 v122, v122
    v_exp_f32 v123, v123
    v_smfmac_f32_32x32x32_bf16 v[48:63], v[168:171], v[112:119], v5
    buffer_load_dwordx4 v234, s[36:39], s94 offen nt lds
    buffer_load_dwordx4 v234, s[36:39], s95 offen offset:1024 nt lds
    v_exp_f32 v124, v124
    v_exp_f32 v125, v125
    v_exp_f32 v126, v126
    v_exp_f32 v127, v127
    v_mfma_f32_32x32x16_bf16 v[144:159], v[160:163], v[32:35], 0
    v_exp_f32 v128, v128
    v_exp_f32 v129, v129
    v_exp_f32 v130, v130
    v_exp_f32 v131, v131
    v_mfma_f32_32x32x16_bf16 v[144:159], v[164:167], v[36:39], v[144:159]
    v_exp_f32 v132, v132
    v_exp_f32 v133, v133
    v_exp_f32 v134, v134
    v_exp_f32 v135, v135
    v_smfmac_f32_32x32x32_bf16 v[48:63], v[172:175], v[120:127], v5
    v_exp_f32 v136, v136
    v_exp_f32 v137, v137
    v_exp_f32 v138, v138
    v_exp_f32 v139, v139
    v_smfmac_f32_32x32x32_bf16 v[64:79], v[168:171], v[128:135], v5
L_hop_in0:
L_hop_0:
    s_cbranch_execz L_hop_1
    v_exp_f32 v140, v140
    v_exp_f32 v141, v141
    v_exp_f32 v142, v142
    v_exp_f32 v143, v143
    v_mfma_f32_32x32x16_bf16 v[112:127], v[160:163], v[40:43], 0
    v_exp_f32 v144, v144
    v_exp_f32 v145, v145
    v_exp_f32 v146, v146
    v_exp_f32 v147, v147
    v_mfma_f32_32x32x16_bf16 v[112:127], v[164:167], v[44:47], v[112:127]
    v_exp_f32 v148, v148
    v_exp_f32 v149, v149
    v_exp_f32 v150, v150
    v_exp_f32 v151, v151
    v_smfmac_f32_32x32x32_bf16 v[64:79], v[172:175], v[136:143], v5
    v_exp_f32 v152, v152
    v_exp_f32 v153, v153
    v_exp_f32 v154, v154
    v_exp_f32 v155, v155
    v_smfmac_f32_32x32x32_bf16 v[80:95], v[168:171], v[144:151], v5
    s_waitcnt vmcnt(4)
    v_exp_f32 v156, v156
    v_exp_f32 v157, v157
    v_exp_f32 v158, v158
    v_exp_f32 v159, v159
    v_mfma_f32_32x32x16_bf16 v[128:143], v[176:179], v[16:19], 0
    s_waitcnt vmcnt(3)
    v_cmp_ne_u32 s[92:93], s66, v224
    s_cmp_lg_u64 s[92:93], 0
    s_cbranch_scc1 L_x1g0_spin_8
L_x1g0_ok_9:
    buffer_load_dwordx4 v[192:195], v1, s[24:27], s7 offen offset:0 sc1
    buffer_load_dwordx4 v[196:199], v1, s[24:27], s7 offen offset:1024 sc1
    buffer_load_dwordx4 v[200:203], v1, s[24:27], s7 offen offset:2048 sc1
    buffer_load_dwordx4 v[204:207], v1, s[24:27], s7 offen offset:3072 sc1
    v_exp_f32 v112, v112
    v_exp_f32 v113, v113
    v_exp_f32 v114, v114
    v_exp_f32 v115, v115
    v_mfma_f32_32x32x16_bf16 v[128:143], v[180:183], v[20:23], v[128:143]
    buffer_load_dwordx4 a[0:3], v3, s[24:27], s7 offen offset:0 sc1
    v_exp_f32 v116, v116
    v_exp_f32 v117, v117
    v_exp_f32 v118, v118
    v_exp_f32 v119, v119
    v_smfmac_f32_32x32x32_bf16 v[80:95], v[172:175], v[152:159], v5
    buffer_load_dwordx4 a[4:7], v3, s[24:27], s7 offen offset:1024 sc1
    v_exp_f32 v120, v120
    v_exp_f32 v121, v121
    v_exp_f32 v122, v122
    v_exp_f32 v123, v123
    v_smfmac_f32_32x32x32_bf16 v[96:111], v[168:171], v[112:119], v5
    buffer_load_dwordx4 a[8:11], v3, s[24:27], s7 offen offset:2048 sc1
    v_exp_f32 v124, v124
    v_exp_f32 v125, v125
    v_exp_f32 v126, v126
    v_exp_f32 v127, v127
    v_mfma_f32_32x32x16_bf16 v[144:159], v[176:179], v[24:27], 0
    buffer_load_dwordx4 a[12:15], v3, s[24:27], s7 offen offset:3072 sc1
    s_add_u32 s7, s7, 32768
    s_and_b32 s7, s7, 786431
    v_exp_f32 v128, v128
    v_exp_f32 v129, v129
    v_exp_f32 v130, v130
    v_exp_f32 v131, v131
    v_mfma_f32_32x32x16_bf16 v[144:159], v[180:183], v[28:31], v[144:159]
    v_exp_f32 v132, v132
    v_exp_f32 v133, v133
    v_exp_f32 v134, v134
    v_exp_f32 v135, v135
    v_smfmac_f32_32x32x32_bf16 v[96:111], v[172:175], v[120:127], v5
    v_exp_f32 v136, v136
    v_exp_f32 v137, v137
    v_exp_f32 v138, v138
    v_exp_f32 v139, v139
    v_smfmac_f32_32x32x32_bf16 v[48:63], v[184:187], v[128:135], v5
    v_exp_f32 v140, v140
    v_exp_f32 v141, v141
    v_exp_f32 v142, v142
    v_exp_f32 v143, v143
    v_mfma_f32_32x32x16_bf16 v[112:127], v[176:179], v[32:35], 0
    v_exp_f32 v144, v144
    v_exp_f32 v145, v145
    v_exp_f32 v146, v146
    v_exp_f32 v147, v147
    v_mfma_f32_32x32x16_bf16 v[112:127], v[180:183], v[36:39], v[112:127]
    s_waitcnt vmcnt(10)
    v_cmp_ne_u32 s[92:93], s66, v225
    s_cmp_lg_u64 s[92:93], 0
    s_cbranch_scc1 L_x1g1_spin_10
L_x1g1_ok_11:
    v_exp_f32 v148, v148
    v_exp_f32 v149, v149
    v_exp_f32 v150, v150
    v_exp_f32 v151, v151
    v_smfmac_f32_32x32x32_bf16 v[48:63], v[188:191], v[136:143], v5
    buffer_load_dwordx4 a[16:19], v1, s[24:27], s7 offen offset:0 sc1
    v_exp_f32 v152, v152
    v_exp_f32 v153, v153
    v_exp_f32 v154, v154
    v_exp_f32 v155, v155
    v_smfmac_f32_32x32x32_bf16 v[64:79], v[184:187], v[144:151], v5
    v_exp_f32 v156, v156
    v_exp_f32 v157, v157
    v_exp_f32 v158, v158
    v_exp_f32 v159, v159
    v_mfma_f32_32x32x16_bf16 v[128:143], v[176:179], v[40:43], 0
    buffer_load_dwordx4 a[20:23], v1, s[24:27], s7 offen offset:1024 sc1
    v_exp_f32 v112, v112
    v_exp_f32 v113, v113
    v_exp_f32 v114, v114
    v_exp_f32 v115, v115
    v_mfma_f32_32x32x16_bf16 v[128:143], v[180:183], v[44:47], v[128:143]
    v_exp_f32 v116, v116
    v_exp_f32 v117, v117
    v_exp_f32 v118, v118
    v_exp_f32 v119, v119
    v_smfmac_f32_32x32x32_bf16 v[64:79], v[188:191], v[152:159], v5
    buffer_load_dwordx4 a[24:27], v1, s[24:27], s7 offen offset:2048 sc1
    v_exp_f32 v120, v120
    v_exp_f32 v121, v121
    v_exp_f32 v122, v122
    v_exp_f32 v123, v123
    v_smfmac_f32_32x32x32_bf16 v[80:95], v[184:187], v[112:119], v5
    s_waitcnt vmcnt(9)
    v_exp_f32 v124, v124
    v_exp_f32 v125, v125
    v_exp_f32 v126, v126
    v_exp_f32 v127, v127
    v_mfma_f32_32x32x16_bf16 v[144:159], v[192:195], v[16:19], 0
    buffer_load_dwordx4 a[28:31], v1, s[24:27], s7 offen offset:3072 sc1
    v_exp_f32 v128, v128
    v_exp_f32 v129, v129
    v_exp_f32 v130, v130
    v_exp_f32 v131, v131
    v_mfma_f32_32x32x16_bf16 v[144:159], v[196:199], v[20:23], v[144:159]
    v_exp_f32 v132, v132
    v_exp_f32 v133, v133
    v_exp_f32 v134, v134
    v_exp_f32 v135, v135
    v_smfmac_f32_32x32x32_bf16 v[80:95], v[188:191], v[120:127], v5
    ds_read_b64_tr_b16 v[216:217], v235 offset:0
    ds_read_b64_tr_b16 v[218:219], v235 offset:512
    v_exp_f32 v136, v136
    v_exp_f32 v137, v137
    v_exp_f32 v138, v138
    v_exp_f32 v139, v139
    v_smfmac_f32_32x32x32_bf16 v[96:111], v[184:187], v[128:135], v5
    ds_read_b64_tr_b16 v[220:221], v235 offset:64
    ds_read_b64_tr_b16 v[222:223], v235 offset:576
    v_exp_f32 v140, v140
    v_exp_f32 v141, v141
    v_exp_f32 v142, v142
    v_exp_f32 v143, v143
    v_mfma_f32_32x32x16_bf16 v[112:127], v[192:195], v[24:27], 0
    buffer_load_dwordx4 a[32:35], v3, s[24:27], s7 offen offset:0 sc1
    v_exp_f32 v144, v144
    v_exp_f32 v145, v145
    v_exp_f32 v146, v146
    v_exp_f32 v147, v147
    v_mfma_f32_32x32x16_bf16 v[112:127], v[196:199], v[28:31], v[112:127]
    s_waitcnt vmcnt(9)
    v_exp_f32 v148, v148
    v_exp_f32 v149, v149
    v_exp_f32 v150, v150
    v_exp_f32 v151, v151
    v_smfmac_f32_32x32x32_bf16 v[96:111], v[188:191], v[136:143], v5
    s_waitcnt lgkmcnt(0)
    v_exp_f32 v152, v152
    v_exp_f32 v153, v153
    v_exp_f32 v154, v154
    v_exp_f32 v155, v155
    v_smfmac_f32_32x32x32_bf16 v[48:63], v[200:203], v[144:151], v5
    buffer_load_dwordx4 a[36:39], v3, s[24:27], s7 offen offset:1024 sc1
    s_buffer_load_dwordx2 s[86:87], s[40:43], s98 offset:60
    v_exp_f32 v156, v156
    v_exp_f32 v157, v157
    v_exp_f32 v158, v158
    v_exp_f32 v159, v159
    v_mfma_f32_32x32x16_bf16 v[128:143], v[192:195], v[32:35], 0
    buffer_load_dwordx4 a[40:43], v3, s[24:27], s7 offen offset:2048 sc1
    v_exp_f32 v112, v112
    v_exp_f32 v113, v113
    v_exp_f32 v114, v114
    v_exp_f32 v115, v115
    v_mfma_f32_32x32x16_bf16 v[128:143], v[196:199], v[36:39], v[128:143]
    buffer_store_dwordx4 v[216:219], v1, s[56:59], s96 offen offset:0 sc1
    v_exp_f32 v116, v116
    v_exp_f32 v117, v117
    v_exp_f32 v118, v118
    v_exp_f32 v119, v119
    v_smfmac_f32_32x32x32_bf16 v[48:63], v[204:207], v[152:159], v5
    buffer_load_dwordx4 a[44:47], v3, s[24:27], s7 offen offset:3072 sc1
    s_add_u32 s7, s7, 32768
    s_and_b32 s7, s7, 786431
    v_exp_f32 v120, v120
    v_exp_f32 v121, v121
    v_exp_f32 v122, v122
    v_exp_f32 v123, v123
    v_smfmac_f32_32x32x32_bf16 v[64:79], v[200:203], v[112:119], v5
    buffer_load_dwordx4 a[48:51], v1, s[24:27], s7 offen offset:0 sc1
    s_buffer_load_dwordx2 s[86:87], s[40:43], s98 offset:3644
    v_exp_f32 v124, v124
    v_exp_f32 v125, v125
    v_exp_f32 v126, v126
    v_exp_f32 v127, v127
    v_mfma_f32_32x32x16_bf16 v[144:159], v[192:195], v[40:43], 0
    buffer_load_dwordx4 v[208:211], v248, s[28:31], s13 offen offset:0
    v_exp_f32 v128, v128
    v_exp_f32 v129, v129
    v_exp_f32 v130, v130
    v_exp_f32 v131, v131
    v_mfma_f32_32x32x16_bf16 v[144:159], v[196:199], v[44:47], v[144:159]
    buffer_load_dwordx4 v[212:215], v248, s[28:31], s13 offen offset:32
    v_exp_f32 v132, v132
    v_exp_f32 v133, v133
    v_exp_f32 v134, v134
    v_exp_f32 v135, v135
    v_smfmac_f32_32x32x32_bf16 v[64:79], v[204:207], v[120:127], v5
    buffer_load_dwordx4 a[52:55], v1, s[24:27], s7 offen offset:1024 sc1
    v_exp_f32 v136, v136
    v_exp_f32 v137, v137
    v_exp_f32 v138, v138
    v_exp_f32 v139, v139
    v_smfmac_f32_32x32x32_bf16 v[80:95], v[200:203], v[128:135], v5
    s_waitcnt vmcnt(13)
    s_buffer_load_dwordx2 s[86:87], s[40:43], s98 offset:7228
    v_exp_f32 v140, v140
    v_exp_f32 v141, v141
    v_exp_f32 v142, v142
    v_exp_f32 v143, v143
    v_mfma_f32_32x32x16_bf16 v[112:127], a[0:3], v[16:19], 0
    buffer_load_dwordx4 a[56:59], v1, s[24:27], s7 offen offset:2048 sc1
    v_exp_f32 v144, v144
    v_exp_f32 v145, v145
    v_exp_f32 v146, v146
    v_exp_f32 v147, v147
    v_mfma_f32_32x32x16_bf16 v[112:127], a[4:7], v[20:23], v[112:127]
    buffer_store_dwordx4 v[220:223], v1, s[56:59], s96 offen offset:1024 sc1
    v_exp_f32 v148, v148
    v_exp_f32 v149, v149
    v_exp_f32 v150, v150
    v_exp_f32 v151, v151
    v_smfmac_f32_32x32x32_bf16 v[80:95], v[204:207], v[136:143], v5
    buffer_load_dwordx4 a[60:63], v1, s[24:27], s7 offen offset:3072 sc1
    v_exp_f32 v152, v152
    v_exp_f32 v153, v153
    v_exp_f32 v154, v154
    v_exp_f32 v155, v155
    v_smfmac_f32_32x32x32_bf16 v[96:111], v[200:203], v[144:151], v5
    s_buffer_load_dwordx2 s[86:87], s[40:43], s98 offset:10812
    v_exp_f32 v156, v156
    v_exp_f32 v157, v157
    v_exp_f32 v158, v158
    v_exp_f32 v159, v159
    v_mfma_f32_32x32x16_bf16 v[128:143], a[0:3], v[24:27], 0
    buffer_load_dwordx4 a[64:67], v3, s[24:27], s7 offen offset:0 sc1
    v_exp_f32 v112, v112
    v_exp_f32 v113, v113
    v_exp_f32 v114, v114
    v_exp_f32 v115, v115
    v_mfma_f32_32x32x16_bf16 v[128:143], a[4:7], v[28:31], v[128:143]
    v_exp_f32 v116, v116
    v_exp_f32 v117, v117
    v_exp_f32 v118, v118
    v_exp_f32 v119, v119
    v_smfmac_f32_32x32x32_bf16 v[96:111], v[204:207], v[152:159], v5
    buffer_load_dwordx4 a[68:71], v3, s[24:27], s7 offen offset:1024 sc1
    v_exp_f32 v120, v120
    v_exp_f32 v121, v121
    v_exp_f32 v122, v122
    v_exp_f32 v123, v123
    v_smfmac_f32_32x32x32_bf16 v[48:63], a[8:11], v[112:119], v5
    s_buffer_load_dwordx2 s[86:87], s[40:43], s98 offset:14396
    v_exp_f32 v124, v124
    v_exp_f32 v125, v125
    v_exp_f32 v126, v126
    v_exp_f32 v127, v127
    v_mfma_f32_32x32x16_bf16 v[144:159], a[0:3], v[32:35], 0
    buffer_load_dwordx4 a[72:75], v3, s[24:27], s7 offen offset:2048 sc1
    v_exp_f32 v128, v128
    v_exp_f32 v129, v129
    v_exp_f32 v130, v130
    v_exp_f32 v131, v131
    v_mfma_f32_32x32x16_bf16 v[144:159], a[4:7], v[36:39], v[144:159]
    v_exp_f32 v132, v132
    v_exp_f32 v133, v133
    v_exp_f32 v134, v134
    v_exp_f32 v135, v135
    v_smfmac_f32_32x32x32_bf16 v[48:63], a[12:15], v[120:127], v5
    buffer_load_dwordx4 a[76:79], v3, s[24:27], s7 offen offset:3072 sc1
    s_add_u32 s7, s7, 32768
    s_and_b32 s7, s7, 786431
    v_exp_f32 v136, v136
    v_exp_f32 v137, v137
    v_exp_f32 v138, v138
    v_exp_f32 v139, v139
    v_smfmac_f32_32x32x32_bf16 v[64:79], a[8:11], v[128:135], v5
    s_buffer_load_dwordx2 s[86:87], s[40:43], s98 offset:17980
    v_exp_f32 v140, v140
    v_exp_f32 v141, v141
    v_exp_f32 v142, v142
    v_exp_f32 v143, v143
    v_mfma_f32_32x32x16_bf16 v[112:127], a[0:3], v[40:43], 0
    buffer_load_dwordx4 a[80:83], v1, s[24:27], s7 offen offset:0 sc1
    v_exp_f32 v144, v144
    v_exp_f32 v145, v145
    v_exp_f32 v146, v146
    v_exp_f32 v147, v147
    v_mfma_f32_32x32x16_bf16 v[112:127], a[4:7], v[44:47], v[112:127]
    v_exp_f32 v148, v148
    v_exp_f32 v149, v149
    v_exp_f32 v150, v150
    v_exp_f32 v151, v151
    v_smfmac_f32_32x32x32_bf16 v[64:79], a[12:15], v[136:143], v5
    buffer_load_dwordx4 a[84:87], v1, s[24:27], s7 offen offset:1024 sc1
    v_exp_f32 v152, v152
    v_exp_f32 v153, v153
    v_exp_f32 v154, v154
    v_exp_f32 v155, v155
    v_smfmac_f32_32x32x32_bf16 v[80:95], a[8:11], v[144:151], v5
    s_waitcnt vmcnt(18)
    s_buffer_load_dwordx2 s[86:87], s[40:43], s98 offset:21564
    v_exp_f32 v156, v156
    v_exp_f32 v157, v157
    v_exp_f32 v158, v158
    v_exp_f32 v159, v159
    v_mfma_f32_32x32x16_bf16 v[128:143], a[16:19], v[16:19], 0
    buffer_load_dwordx4 a[88:91], v1, s[24:27], s7 offen offset:2048 sc1
    v_exp_f32 v112, v112
    v_exp_f32 v113, v113
    v_exp_f32 v114, v114
    v_exp_f32 v115, v115
    v_mfma_f32_32x32x16_bf16 v[128:143], a[20:23], v[20:23], v[128:143]
    v_exp_f32 v116, v116
    v_exp_f32 v117, v117
    v_exp_f32 v118, v118
    v_exp_f32 v119, v119
    v_smfmac_f32_32x32x32_bf16 v[80:95], a[12:15], v[152:159], v5
    buffer_load_dwordx4 a[92:95], v1, s[24:27], s7 offen offset:3072 sc1
    v_exp_f32 v120, v120
    v_exp_f32 v121, v121
    v_exp_f32 v122, v122
    v_exp_f32 v123, v123
    v_smfmac_f32_32x32x32_bf16 v[96:111], a[8:11], v[112:119], v5
    s_buffer_load_dwordx2 s[86:87], s[40:43], s98 offset:25148
    v_exp_f32 v124, v124
    v_exp_f32 v125, v125
    v_exp_f32 v126, v126
    v_exp_f32 v127, v127
    v_mfma_f32_32x32x16_bf16 v[144:159], a[16:19], v[24:27], 0
    buffer_load_dwordx4 a[192:195], v3, s[24:27], s7 offen offset:0 sc1
    v_exp_f32 v128, v128
    v_exp_f32 v129, v129
    v_exp_f32 v130, v130
    v_exp_f32 v131, v131
    v_mfma_f32_32x32x16_bf16 v[144:159], a[20:23], v[28:31], v[144:159]
    v_exp_f32 v132, v132
    v_exp_f32 v133, v133
    v_exp_f32 v134, v134
    v_exp_f32 v135, v135
    v_smfmac_f32_32x32x32_bf16 v[96:111], a[12:15], v[120:127], v5
    buffer_load_dwordx4 a[196:199], v3, s[24:27], s7 offen offset:1024 sc1
    v_exp_f32 v136, v136
    v_exp_f32 v137, v137
    v_exp_f32 v138, v138
    v_exp_f32 v139, v139
    v_smfmac_f32_32x32x32_bf16 v[48:63], a[24:27], v[128:135], v5
    s_buffer_load_dwordx2 s[86:87], s[40:43], s98 offset:28732
    v_exp_f32 v140, v140
    v_exp_f32 v141, v141
    v_exp_f32 v142, v142
    v_exp_f32 v143, v143
    v_mfma_f32_32x32x16_bf16 v[112:127], a[16:19], v[32:35], 0
    buffer_load_dwordx4 a[200:203], v3, s[24:27], s7 offen offset:2048 sc1
    v_exp_f32 v144, v144
    v_exp_f32 v145, v145
    v_exp_f32 v146, v146
    v_exp_f32 v147, v147
    v_mfma_f32_32x32x16_bf16 v[112:127], a[20:23], v[36:39], v[112:127]
    v_exp_f32 v148, v148
    v_exp_f32 v149, v149
    v_exp_f32 v150, v150
    v_exp_f32 v151, v151
    v_smfmac_f32_32x32x32_bf16 v[48:63], a[28:31], v[136:143], v5
    buffer_load_dwordx4 a[204:207], v3, s[24:27], s7 offen offset:3072 sc1
    s_add_u32 s7, s7, 32768
    s_and_b32 s7, s7, 786431
    v_exp_f32 v152, v152
    v_exp_f32 v153, v153
    v_exp_f32 v154, v154
    v_exp_f32 v155, v155
    v_smfmac_f32_32x32x32_bf16 v[64:79], a[24:27], v[144:151], v5
    s_buffer_load_dwordx2 s[86:87], s[40:43], s98 offset:32316
    v_exp_f32 v156, v156
    v_exp_f32 v157, v157
    v_exp_f32 v158, v158
    v_exp_f32 v159, v159
    v_mfma_f32_32x32x16_bf16 v[128:143], a[16:19], v[40:43], 0
    buffer_load_dwordx4 a[208:211], v1, s[24:27], s7 offen offset:0 sc1
    v_exp_f32 v112, v112
    v_exp_f32 v113, v113
    v_exp_f32 v114, v114
    v_exp_f32 v115, v115
    v_mfma_f32_32x32x16_bf16 v[128:143], a[20:23], v[44:47], v[128:143]
    v_exp_f32 v116, v116
    v_exp_f32 v117, v117
    v_exp_f32 v118, v118
    v_exp_f32 v119, v119
    v_smfmac_f32_32x32x32_bf16 v[64:79], a[28:31], v[152:159], v5
    buffer_load_dwordx4 a[212:215], v1, s[24:27], s7 offen offset:1024 sc1
    v_exp_f32 v120, v120
    v_exp_f32 v121, v121
    v_exp_f32 v122, v122
    v_exp_f32 v123, v123
    v_smfmac_f32_32x32x32_bf16 v[80:95], a[24:27], v[112:119], v5
    s_waitcnt vmcnt(21)
    s_buffer_load_dwordx2 s[86:87], s[40:43], s98 offset:35900
    v_exp_f32 v124, v124
    v_exp_f32 v125, v125
    v_exp_f32 v126, v126
    v_exp_f32 v127, v127
    v_mfma_f32_32x32x16_bf16 v[144:159], a[32:35], v[16:19], 0
    buffer_load_dwordx4 a[216:219], v1, s[24:27], s7 offen offset:2048 sc1
    v_exp_f32 v128, v128
    v_exp_f32 v129, v129
    v_exp_f32 v130, v130
    v_exp_f32 v131, v131
    v_mfma_f32_32x32x16_bf16 v[144:159], a[36:39], v[20:23], v[144:159]
    s_add_u32 s72, s4, 32768
    s_waitcnt vmcnt(16)
    s_barrier
    buffer_store_dword v4, v2, s[52:55], s72 offen sc1
    v_exp_f32 v132, v132
    v_exp_f32 v133, v133
    v_exp_f32 v134, v134
    v_exp_f32 v135, v135
    v_smfmac_f32_32x32x32_bf16 v[80:95], a[28:31], v[120:127], v5
    buffer_load_dwordx4 a[220:223], v1, s[24:27], s7 offen offset:3072 sc1
    v_exp_f32 v136, v136
    v_exp_f32 v137, v137
    v_exp_f32 v138, v138
    v_exp_f32 v139, v139
    v_smfmac_f32_32x32x32_bf16 v[96:111], a[24:27], v[128:135], v5
    s_buffer_load_dwordx2 s[86:87], s[40:43], s98 offset:39484
    v_exp_f32 v140, v140
    v_exp_f32 v141, v141
    v_exp_f32 v142, v142
    v_exp_f32 v143, v143
    v_mfma_f32_32x32x16_bf16 v[112:127], a[32:35], v[24:27], 0
    buffer_load_dwordx4 a[224:227], v3, s[24:27], s7 offen offset:0 sc1
    v_exp_f32 v144, v144
    v_exp_f32 v145, v145
    v_exp_f32 v146, v146
    v_exp_f32 v147, v147
    v_mfma_f32_32x32x16_bf16 v[112:127], a[36:39], v[28:31], v[112:127]
    v_exp_f32 v148, v148
    v_exp_f32 v149, v149
    v_exp_f32 v150, v150
    v_exp_f32 v151, v151
    v_smfmac_f32_32x32x32_bf16 v[96:111], a[28:31], v[136:143], v5
    buffer_load_dwordx4 a[228:231], v3, s[24:27], s7 offen offset:1024 sc1
    v_exp_f32 v152, v152
    v_exp_f32 v153, v153
    v_exp_f32 v154, v154
    v_exp_f32 v155, v155
    v_smfmac_f32_32x32x32_bf16 v[48:63], a[40:43], v[144:151], v5
    s_buffer_load_dwordx2 s[86:87], s[40:43], s98 offset:43068
    v_exp_f32 v156, v156
    v_exp_f32 v157, v157
    v_exp_f32 v158, v158
    v_exp_f32 v159, v159
    v_mfma_f32_32x32x16_bf16 v[128:143], a[32:35], v[32:35], 0
    buffer_load_dwordx4 a[232:235], v3, s[24:27], s7 offen offset:2048 sc1
    v_exp_f32 v112, v112
    v_exp_f32 v113, v113
    v_exp_f32 v114, v114
    v_exp_f32 v115, v115
    v_mfma_f32_32x32x16_bf16 v[128:143], a[36:39], v[36:39], v[128:143]
    v_exp_f32 v116, v116
    v_exp_f32 v117, v117
    v_exp_f32 v118, v118
    v_exp_f32 v119, v119
    v_smfmac_f32_32x32x32_bf16 v[48:63], a[44:47], v[152:159], v5
    buffer_load_dwordx4 a[236:239], v3, s[24:27], s7 offen offset:3072 sc1
    s_add_u32 s7, s7, 32768
    s_and_b32 s7, s7, 786431
    v_exp_f32 v120, v120
    v_exp_f32 v121, v121
    v_exp_f32 v122, v122
    v_exp_f32 v123, v123
    v_smfmac_f32_32x32x32_bf16 v[64:79], a[40:43], v[112:119], v5
    s_buffer_load_dwordx2 s[86:87], s[40:43], s98 offset:46652
    v_exp_f32 v124, v124
    v_exp_f32 v125, v125
    v_exp_f32 v126, v126
    v_exp_f32 v127, v127
    v_mfma_f32_32x32x16_bf16 v[144:159], a[32:35], v[40:43], 0
    buffer_load_dwordx4 a[240:243], v1, s[24:27], s7 offen offset:0 sc1
    v_exp_f32 v128, v128
    v_exp_f32 v129, v129
    v_exp_f32 v130, v130
    v_exp_f32 v131, v131
    v_mfma_f32_32x32x16_bf16 v[144:159], a[36:39], v[44:47], v[144:159]
    v_exp_f32 v132, v132
    v_exp_f32 v133, v133
    v_exp_f32 v134, v134
    v_exp_f32 v135, v135
    v_smfmac_f32_32x32x32_bf16 v[64:79], a[44:47], v[120:127], v5
    buffer_load_dwordx4 a[244:247], v1, s[24:27], s7 offen offset:1024 sc1
    v_exp_f32 v136, v136
    v_exp_f32 v137, v137
    v_exp_f32 v138, v138
    v_exp_f32 v139, v139
    v_smfmac_f32_32x32x32_bf16 v[80:95], a[40:43], v[128:135], v5
    s_waitcnt vmcnt(23)
    s_buffer_load_dwordx2 s[86:87], s[40:43], s98 offset:50236
    v_exp_f32 v140, v140
    v_exp_f32 v141, v141
    v_exp_f32 v142, v142
    v_exp_f32 v143, v143
    v_mfma_f32_32x32x16_bf16 v[112:127], a[48:51], v[16:19], 0
    buffer_load_dwordx4 a[248:251], v1, s[24:27], s7 offen offset:2048 sc1
    v_exp_f32 v144, v144
    v_exp_f32 v145, v145
    v_exp_f32 v146, v146
    v_exp_f32 v147, v147
    v_mfma_f32_32x32x16_bf16 v[112:127], a[52:55], v[20:23], v[112:127]
    v_exp_f32 v148, v148
    v_exp_f32 v149, v149
    v_exp_f32 v150, v150
    v_exp_f32 v151, v151
    v_smfmac_f32_32x32x32_bf16 v[80:95], a[44:47], v[136:143], v5
    buffer_load_dwordx4 a[252:255], v1, s[24:27], s7 offen offset:3072 sc1
    v_exp_f32 v152, v152
    v_exp_f32 v153, v153
    v_exp_f32 v154, v154
    v_exp_f32 v155, v155
    v_smfmac_f32_32x32x32_bf16 v[96:111], a[40:43], v[144:151], v5
    s_add_u32 m0, s76, s99
    s_mul_i32 s101, s76, 28
    v_exp_f32 v156, v156
    v_exp_f32 v157, v157
    v_exp_f32 v158, v158
    v_exp_f32 v159, v159
    v_mfma_f32_32x32x16_bf16 v[128:143], a[48:51], v[24:27], 0
    buffer_load_dwordx4 v233, s[40:43], s101 offen offset:0 lds
    v_exp_f32 v112, v112
    v_exp_f32 v113, v113
    v_exp_f32 v114, v114
    v_exp_f32 v115, v115
    v_mfma_f32_32x32x16_bf16 v[128:143], a[52:55], v[28:31], v[128:143]
    s_buffer_load_dwordx2 s[86:87], s[40:43], s98 offset:53820
    v_exp_f32 v116, v116
    v_exp_f32 v117, v117
    v_exp_f32 v118, v118
    v_exp_f32 v119, v119
    v_smfmac_f32_32x32x32_bf16 v[96:111], a[44:47], v[152:159], v5
    buffer_load_dwordx4 v[160:163], v3, s[24:27], s7 offen offset:0 sc1
    v_exp_f32 v120, v120
    v_exp_f32 v121, v121
    v_exp_f32 v122, v122
    v_exp_f32 v123, v123
    v_smfmac_f32_32x32x32_bf16 v[48:63], a[56:59], v[112:119], v5
    s_add_u32 m0, s77, s99
    s_mul_i32 s101, s77, 28
    v_exp_f32 v124, v124
    v_exp_f32 v125, v125
    v_exp_f32 v126, v126
    v_exp_f32 v127, v127
    v_mfma_f32_32x32x16_bf16 v[144:159], a[48:51], v[32:35], 0
    buffer_load_dwordx4 v233, s[40:43], s101 offen offset:0 lds
    v_exp_f32 v128, v128
    v_exp_f32 v129, v129
    v_exp_f32 v130, v130
    v_exp_f32 v131, v131
    v_mfma_f32_32x32x16_bf16 v[144:159], a[52:55], v[36:39], v[144:159]
    s_buffer_load_dwordx2 s[86:87], s[40:43], s98 offset:57404
    v_exp_f32 v132, v132
    v_exp_f32 v133, v133
    v_exp_f32 v134, v134
    v_exp_f32 v135, v135
    v_smfmac_f32_32x32x32_bf16 v[48:63], a[60:63], v[120:127], v5
    buffer_load_dwordx4 v[164:167], v3, s[24:27], s7 offen offset:1024 sc1
    v_exp_f32 v136, v136
    v_exp_f32 v137, v137
    v_exp_f32 v138, v138
    v_exp_f32 v139, v139
    v_smfmac_f32_32x32x32_bf16 v[64:79], a[56:59], v[128:135], v5
    s_add_u32 m0, s78, s99
    s_mul_i32 s101, s78, 28
    v_exp_f32 v140, v140
    v_exp_f32 v141, v141
    v_exp_f32 v142, v142
    v_exp_f32 v143, v143
    v_mfma_f32_32x32x16_bf16 v[112:127], a[48:51], v[40:43], 0
    buffer_load_dwordx4 v233, s[40:43], s101 offen offset:0 lds
    v_exp_f32 v144, v144
    v_exp_f32 v145, v145
    v_exp_f32 v146, v146
    v_exp_f32 v147, v147
    v_mfma_f32_32x32x16_bf16 v[112:127], a[52:55], v[44:47], v[112:127]
    s_buffer_load_dwordx2 s[86:87], s[40:43], s98 offset:60988
    v_exp_f32 v148, v148
    v_exp_f32 v149, v149
    v_exp_f32 v150, v150
    v_exp_f32 v151, v151
    v_smfmac_f32_32x32x32_bf16 v[64:79], a[60:63], v[136:143], v5
    buffer_load_dwordx4 v[168:171], v3, s[24:27], s7 offen offset:2048 sc1
    v_exp_f32 v152, v152
    v_exp_f32 v153, v153
    v_exp_f32 v154, v154
    v_exp_f32 v155, v155
    v_smfmac_f32_32x32x32_bf16 v[80:95], a[56:59], v[144:151], v5
    s_waitcnt vmcnt(27)
    s_add_u32 m0, s79, s99
    s_mul_i32 s101, s79, 28
    v_exp_f32 v156, v156
    v_exp_f32 v157, v157
    v_exp_f32 v158, v158
    v_exp_f32 v159, v159
    v_mfma_f32_32x32x16_bf16 v[128:143], a[64:67], v[16:19], 0
    buffer_load_dwordx4 v233, s[40:43], s101 offen offset:0 lds
    v_exp_f32 v112, v112
    v_exp_f32 v113, v113
    v_exp_f32 v114, v114
    v_exp_f32 v115, v115
    v_mfma_f32_32x32x16_bf16 v[128:143], a[68:71], v[20:23], v[128:143]
    s_buffer_load_dwordx2 s[86:87], s[40:43], s98 offset:64572
    v_exp_f32 v116, v116
    v_exp_f32 v117, v117
    v_exp_f32 v118, v118
    v_exp_f32 v119, v119
    v_smfmac_f32_32x32x32_bf16 v[80:95], a[60:63], v[152:159], v5
    buffer_load_dwordx4 v[172:175], v3, s[24:27], s7 offen offset:3072 sc1
    s_add_u32 s7, s7, 32768
    s_and_b32 s7, s7, 786431
    v_exp_f32 v120, v120
    v_exp_f32 v121, v121
    v_exp_f32 v122, v122
    v_exp_f32 v123, v123
    v_smfmac_f32_32x32x32_bf16 v[96:111], a[56:59], v[112:119], v5
    s_buffer_load_dwordx2 s[86:87], s[40:43], s98 offset:68156
    v_exp_f32 v124, v124
    v_exp_f32 v125, v125
    v_exp_f32 v126, v126
    v_exp_f32 v127, v127
    v_mfma_f32_32x32x16_bf16 v[144:159], a[64:67], v[24:27], 0
    buffer_load_dwordx4 v[176:179], v1, s[24:27], s7 offen offset:0 sc1
    v_exp_f32 v128, v128
    v_exp_f32 v129, v129
    v_exp_f32 v130, v130
    v_exp_f32 v131, v131
    v_mfma_f32_32x32x16_bf16 v[144:159], a[68:71], v[28:31], v[144:159]
    v_exp_f32 v132, v132
    v_exp_f32 v133, v133
    v_exp_f32 v134, v134
    v_exp_f32 v135, v135
    v_smfmac_f32_32x32x32_bf16 v[96:111], a[60:63], v[120:127], v5
    buffer_load_dwordx4 v[180:183], v1, s[24:27], s7 offen offset:1024 sc1
    v_exp_f32 v136, v136
    v_exp_f32 v137, v137
    v_exp_f32 v138, v138
    v_exp_f32 v139, v139
    v_smfmac_f32_32x32x32_bf16 v[48:63], a[72:75], v[128:135], v5
    s_add_u32 m0, s80, s99
    s_mul_i32 s101, s80, 28
    v_exp_f32 v140, v140
    v_exp_f32 v141, v141
    v_exp_f32 v142, v142
    v_exp_f32 v143, v143
    v_mfma_f32_32x32x16_bf16 v[112:127], a[64:67], v[32:35], 0
    buffer_load_dwordx4 v233, s[40:43], s101 offen offset:0 lds
    v_exp_f32 v144, v144
    v_exp_f32 v145, v145
    v_exp_f32 v146, v146
    v_exp_f32 v147, v147
    v_mfma_f32_32x32x16_bf16 v[112:127], a[68:71], v[36:39], v[112:127]
    buffer_load_dword v224, v231, s[24:27], 0 offen sc1
    v_exp_f32 v148, v148
    v_exp_f32 v149, v149
    v_exp_f32 v150, v150
    v_exp_f32 v151, v151
    v_smfmac_f32_32x32x32_bf16 v[48:63], a[76:79], v[136:143], v5
    buffer_load_dwordx4 v[184:187], v1, s[24:27], s7 offen offset:2048 sc1
    s_buffer_load_dwordx2 s[86:87], s[40:43], s98 offset:71740
    v_exp_f32 v152, v152
    v_exp_f32 v153, v153
    v_exp_f32 v154, v154
    v_exp_f32 v155, v155
    v_smfmac_f32_32x32x32_bf16 v[64:79], a[72:75], v[144:151], v5
    s_add_u32 m0, s81, s99
    s_mul_i32 s101, s81, 28
    v_exp_f32 v156, v156
    v_exp_f32 v157, v157
    v_exp_f32 v158, v158
    v_exp_f32 v159, v159
    v_mfma_f32_32x32x16_bf16 v[128:143], a[64:67], v[40:43], 0
    buffer_load_dwordx4 v233, s[40:43], s101 offen offset:0 lds
    v_exp_f32 v112, v112
    v_exp_f32 v113, v113
    v_exp_f32 v114, v114
    v_exp_f32 v115, v115
    v_mfma_f32_32x32x16_bf16 v[128:143], a[68:71], v[44:47], v[128:143]
    s_buffer_load_dwordx2 s[86:87], s[40:43], s98 offset:75324
    v_exp_f32 v116, v116
    v_exp_f32 v117, v117
    v_exp_f32 v118, v118
    v_exp_f32 v119, v119
    v_smfmac_f32_32x32x32_bf16 v[64:79], a[76:79], v[152:159], v5
    buffer_load_dwordx4 v[188:191], v1, s[24:27], s7 offen offset:3072 sc1
    v_exp_f32 v120, v120
    v_exp_f32 v121, v121
    v_exp_f32 v122, v122
    v_exp_f32 v123, v123
    v_smfmac_f32_32x32x32_bf16 v[80:95], a[72:75], v[112:119], v5
    s_waitcnt vmcnt(32)
    s_add_u32 m0, s82, s99
    s_mul_i32 s101, s82, 28
    v_exp_f32 v124, v124
    v_exp_f32 v125, v125
    v_exp_f32 v126, v126
    v_exp_f32 v127, v127
    v_mfma_f32_32x32x16_bf16 v[144:159], a[80:83], v[16:19], 0
    buffer_load_dwordx4 v233, s[40:43], s101 offen offset:0 lds
    v_exp_f32 v128, v128
    v_exp_f32 v129, v129
    v_exp_f32 v130, v130
    v_exp_f32 v131, v131
    v_mfma_f32_32x32x16_bf16 v[144:159], a[84:87], v[20:23], v[144:159]
    s_buffer_load_dwordx2 s[86:87], s[40:43], s98 offset:78908
    v_exp_f32 v132, v132
    v_exp_f32 v133, v133
    v_exp_f32 v134, v134
    v_exp_f32 v135, v135
    v_smfmac_f32_32x32x32_bf16 v[80:95], a[76:79], v[120:127], v5
    buffer_load_dwordx4 v[192:195], v3, s[24:27], s7 offen offset:0 sc1
    v_exp_f32 v136, v136
    v_exp_f32 v137, v137
    v_exp_f32 v138, v138
    v_exp_f32 v139, v139
    v_smfmac_f32_32x32x32_bf16 v[96:111], a[72:75], v[128:135], v5
    s_buffer_load_dwordx2 s[86:87], s[40:43], s98 offset:82492
    v_exp_f32 v140, v140
    v_exp_f32 v141, v141
    v_exp_f32 v142, v142
    v_exp_f32 v143, v143
    v_mfma_f32_32x32x16_bf16 v[112:127], a[80:83], v[24:27], 0
    buffer_load_dwordx4 v[196:199], v3, s[24:27], s7 offen offset:1024 sc1
    v_exp_f32 v144, v144
    v_exp_f32 v145, v145
    v_exp_f32 v146, v146
    v_exp_f32 v147, v147
    v_mfma_f32_32x32x16_bf16 v[112:127], a[84:87], v[28:31], v[112:127]
    v_exp_f32 v148, v148
    v_exp_f32 v149, v149
    v_exp_f32 v150, v150
    v_exp_f32 v151, v151
    v_smfmac_f32_32x32x32_bf16 v[96:111], a[76:79], v[136:143], v5
    buffer_load_dwordx4 v[200:203], v3, s[24:27], s7 offen offset:2048 sc1
    v_exp_f32 v152, v152
    v_exp_f32 v153, v153
    v_exp_f32 v154, v154
    v_exp_f32 v155, v155
    v_smfmac_f32_32x32x32_bf16 v[48:63], a[88:91], v[144:151], v5
    s_add_u32 m0, s76, s99
    s_mul_i32 s101, s76, 28
    v_add_u32 v233, 27648, v233
    v_exp_f32 v156, v156
    v_exp_f32 v157, v157
    v_exp_f32 v158, v158
    v_exp_f32 v159, v159
    v_mfma_f32_32x32x16_bf16 v[128:143], a[80:83], v[32:35], 0
    buffer_load_dwordx4 v233, s[40:43], s101 offen offset:1024 lds
    s_buffer_load_dwordx2 s[86:87], s[40:43], s98 offset:86076
    v_exp_f32 v112, v112
    v_exp_f32 v113, v113
    v_exp_f32 v114, v114
    v_exp_f32 v115, v115
    v_mfma_f32_32x32x16_bf16 v[128:143], a[84:87], v[36:39], v[128:143]
    s_waitcnt vmcnt(8)
    v_cmp_ne_u32 vcc, v253, v224
    s_mov_b32 s3, 1
    s_cbranch_vccnz L_fb_slow
L_fb_ok:
    v_exp_f32 v116, v116
    v_exp_f32 v117, v117
    v_exp_f32 v118, v118
    v_exp_f32 v119, v119
    v_smfmac_f32_32x32x32_bf16 v[48:63], a[92:95], v[152:159], v5
L_hop_in1:
L_hop_1:
    s_cbranch_execz L_hop_2
    buffer_load_dwordx4 v[204:207], v3, s[24:27], s7 offen offset:3072 sc1
    s_add_u32 s7, s7, 32768
    s_and_b32 s7, s7, 786431
    v_exp_f32 v120, v120
    v_exp_f32 v121, v121
    v_exp_f32 v122, v122
    v_exp_f32 v123, v123
    v_smfmac_f32_32x32x32_bf16 v[64:79], a[88:91], v[112:119], v5
    s_add_u32 m0, s77, s99
    s_mul_i32 s101, s77, 28
    v_exp_f32 v124, v124
    v_exp_f32 v125, v125
    v_exp_f32 v126, v126
    v_exp_f32 v127, v127
    v_mfma_f32_32x32x16_bf16 v[144:159], a[80:83], v[40:43], 0
    buffer_load_dwordx4 v233, s[40:43], s101 offen offset:1024 lds
    v_exp_f32 v128, v128
    v_exp_f32 v129, v129
    v_exp_f32 v130, v130
    v_exp_f32 v131, v131
    v_mfma_f32_32x32x16_bf16 v[144:159], a[84:87], v[44:47], v[144:159]
    s_buffer_load_dwordx2 s[86:87], s[40:43], s98 offset:89660
    v_exp_f32 v132, v132
    v_exp_f32 v133, v133
    v_exp_f32 v134, v134
    v_exp_f32 v135, v135
    v_smfmac_f32_32x32x32_bf16 v[64:79], a[92:95], v[120:127], v5
    buffer_load_dwordx4 a[0:3], v1, s[32:35], s8 offen offset:0 sc1
    v_exp_f32 v136, v136
    v_exp_f32 v137, v137
    v_exp_f32 v138, v138
    v_exp_f32 v139, v139
    v_smfmac_f32_32x32x32_bf16 v[80:95], a[88:91], v[128:135], v5
    s_add_u32 m0, s78, s99
    s_mul_i32 s101, s78, 28
    v_exp_f32 v140, v140
    v_exp_f32 v141, v141
    v_exp_f32 v142, v142
    v_exp_f32 v143, v143
    v_mfma_f32_32x32x16_bf16 v[112:127], a[192:195], v[16:19], 0
    buffer_load_dwordx4 v233, s[40:43], s101 offen offset:1024 lds
    v_exp_f32 v144, v144
    v_exp_f32 v145, v145
    v_exp_f32 v146, v146
    v_exp_f32 v147, v147
    v_mfma_f32_32x32x16_bf16 v[112:127], a[196:199], v[20:23], v[112:127]
    s_buffer_load_dwordx2 s[86:87], s[40:43], s98 offset:93244
    v_exp_f32 v148, v148
    v_exp_f32 v149, v149
    v_exp_f32 v150, v150
    v_exp_f32 v151, v151
    v_smfmac_f32_32x32x32_bf16 v[80:95], a[92:95], v[136:143], v5
    buffer_load_dwordx4 a[4:7], v1, s[32:35], s8 offen offset:2048 sc1
    v_exp_f32 v152, v152
    v_exp_f32 v153, v153
    v_exp_f32 v154, v154
    v_exp_f32 v155, v155
    v_smfmac_f32_32x32x32_bf16 v[96:111], a[88:91], v[144:151], v5
    s_buffer_load_dwordx2 s[86:87], s[40:43], s98 offset:96828
    v_exp_f32 v156, v156
    v_exp_f32 v157, v157
    v_exp_f32 v158, v158
    v_exp_f32 v159, v159
    v_mfma_f32_32x32x16_bf16 v[128:143], a[192:195], v[24:27], 0
    buffer_load_dwordx4 a[8:11], v3, s[32:35], s8 offen offset:0 sc1
    v_exp_f32 v112, v112
    v_exp_f32 v113, v113
    v_exp_f32 v114, v114
    v_exp_f32 v115, v115
    v_mfma_f32_32x32x16_bf16 v[128:143], a[196:199], v[28:31], v[128:143]
    v_exp_f32 v116, v116
    v_exp_f32 v117, v117
    v_exp_f32 v118, v118
    v_exp_f32 v119, v119
    v_smfmac_f32_32x32x32_bf16 v[96:111], a[92:95], v[152:159], v5
    buffer_load_dwordx4 a[12:15], v3, s[32:35], s8 offen offset:2048 sc1
    v_exp_f32 v120, v120
    v_exp_f32 v121, v121
    v_exp_f32 v122, v122
    v_exp_f32 v123, v123
    v_smfmac_f32_32x32x32_bf16 v[48:63], a[200:203], v[112:119], v5
    s_add_u32 m0, s79, s99
    s_mul_i32 s101, s79, 28
    v_exp_f32 v124, v124
    v_exp_f32 v125, v125
    v_exp_f32 v126, v126
    v_exp_f32 v127, v127
    v_mfma_f32_32x32x16_bf16 v[144:159], a[192:195], v[32:35], 0
    buffer_load_dwordx4 v233, s[40:43], s101 offen offset:1024 lds
    v_exp_f32 v128, v128
    v_exp_f32 v129, v129
    v_exp_f32 v130, v130
    v_exp_f32 v131, v131
    v_mfma_f32_32x32x16_bf16 v[144:159], a[196:199], v[36:39], v[144:159]
    s_add_u32 s8, s8, 8192
    v_exp_f32 v132, v132
    v_exp_f32 v133, v133
    v_exp_f32 v134, v134
    v_exp_f32 v135, v135
    v_smfmac_f32_32x32x32_bf16 v[48:63], a[204:207], v[120:127], v5
    buffer_load_dwordx4 a[16:19], v1, s[32:35], s8 offen offset:0 sc1
    s_buffer_load_dwordx2 s[86:87], s[40:43], s98 offset:100412
    v_exp_f32 v136, v136
    v_exp_f32 v137, v137
    v_exp_f32 v138, v138
    v_exp_f32 v139, v139
    v_smfmac_f32_32x32x32_bf16 v[64:79], a[200:203], v[128:135], v5
    s_add_u32 m0, s80, s99
    s_mul_i32 s101, s80, 28
    v_exp_f32 v140, v140
    v_exp_f32 v141, v141
    v_exp_f32 v142, v142
    v_exp_f32 v143, v143
    v_mfma_f32_32x32x16_bf16 v[112:127], a[192:195], v[40:43], 0
    buffer_load_dwordx4 v233, s[40:43], s101 offen offset:1024 lds
    v_exp_f32 v144, v144
    v_exp_f32 v145, v145
    v_exp_f32 v146, v146
    v_exp_f32 v147, v147
    v_mfma_f32_32x32x16_bf16 v[112:127], a[196:199], v[44:47], v[112:127]
    s_buffer_load_dwordx2 s[86:87], s[40:43], s98 offset:103996
    v_exp_f32 v148, v148
    v_exp_f32 v149, v149
    v_exp_f32 v150, v150
    v_exp_f32 v151, v151
    v_smfmac_f32_32x32x32_bf16 v[64:79], a[204:207], v[136:143], v5
    buffer_load_dwordx4 a[20:23], v1, s[32:35], s8 offen offset:2048 sc1
    v_exp_f32 v152, v152
    v_exp_f32 v153, v153
    v_exp_f32 v154, v154
    v_exp_f32 v155, v155
    v_smfmac_f32_32x32x32_bf16 v[80:95], a[200:203], v[144:151], v5
    s_add_u32 m0, s81, s99
    s_mul_i32 s101, s81, 28
    v_exp_f32 v156, v156
    v_exp_f32 v157, v157
    v_exp_f32 v158, v158
    v_exp_f32 v159, v159
    v_mfma_f32_32x32x16_bf16 v[128:143], a[208:211], v[16:19], 0
    buffer_load_dwordx4 v233, s[40:43], s101 offen offset:1024 lds
    v_exp_f32 v112, v112
    v_exp_f32 v113, v113
    v_exp_f32 v114, v114
    v_exp_f32 v115, v115
    v_mfma_f32_32x32x16_bf16 v[128:143], a[212:215], v[20:23], v[128:143]
    s_buffer_load_dwordx2 s[86:87], s[40:43], s98 offset:107580
    v_exp_f32 v116, v116
    v_exp_f32 v117, v117
    v_exp_f32 v118, v118
    v_exp_f32 v119, v119
    v_smfmac_f32_32x32x32_bf16 v[80:95], a[204:207], v[152:159], v5
    buffer_load_dwordx4 a[24:27], v3, s[32:35], s8 offen offset:0 sc1
    v_exp_f32 v120, v120
    v_exp_f32 v121, v121
    v_exp_f32 v122, v122
    v_exp_f32 v123, v123
    v_smfmac_f32_32x32x32_bf16 v[96:111], a[200:203], v[112:119], v5
    s_buffer_load_dwordx2 s[86:87], s[40:43], s98 offset:111164
    v_exp_f32 v124, v124
    v_exp_f32 v125, v125
    v_exp_f32 v126, v126
    v_exp_f32 v127, v127
    v_mfma_f32_32x32x16_bf16 v[144:159], a[208:211], v[24:27], 0
    buffer_load_dwordx4 a[28:31], v3, s[32:35], s8 offen offset:2048 sc1
    v_exp_f32 v128, v128
    v_exp_f32 v129, v129
    v_exp_f32 v130, v130
    v_exp_f32 v131, v131
    v_mfma_f32_32x32x16_bf16 v[144:159], a[212:215], v[28:31], v[144:159]
    s_add_u32 s8, s8, 8192
    v_exp_f32 v132, v132
    v_exp_f32 v133, v133
    v_exp_f32 v134, v134
    v_exp_f32 v135, v135
    v_smfmac_f32_32x32x32_bf16 v[96:111], a[204:207], v[120:127], v5
    buffer_load_dwordx4 a[32:35], v1, s[32:35], s8 offen offset:0 sc1
    v_exp_f32 v136, v136
    v_exp_f32 v137, v137
    v_exp_f32 v138, v138
    v_exp_f32 v139, v139
    v_smfmac_f32_32x32x32_bf16 v[48:63], a[216:219], v[128:135], v5
    s_add_u32 m0, s82, s99
    s_mul_i32 s101, s82, 28
    v_exp_f32 v140, v140
    v_exp_f32 v141, v141
    v_exp_f32 v142, v142
    v_exp_f32 v143, v143
    v_mfma_f32_32x32x16_bf16 v[112:127], a[208:211], v[32:35], 0
    buffer_load_dwordx4 v233, s[40:43], s101 offen offset:1024 lds
    v_exp_f32 v144, v144
    v_exp_f32 v145, v145
    v_exp_f32 v146, v146
    v_exp_f32 v147, v147
    v_mfma_f32_32x32x16_bf16 v[112:127], a[212:215], v[36:39], v[112:127]
    v_exp_f32 v148, v148
    v_exp_f32 v149, v149
    v_exp_f32 v150, v150
    v_exp_f32 v151, v151
    v_smfmac_f32_32x32x32_bf16 v[48:63], a[220:223], v[136:143], v5
    buffer_load_dwordx4 a[36:39], v1, s[32:35], s8 offen offset:2048 sc1
    v_exp_f32 v152, v152
    v_exp_f32 v153, v153
    v_exp_f32 v154, v154
    v_exp_f32 v155, v155
    v_smfmac_f32_32x32x32_bf16 v[64:79], a[216:219], v[144:151], v5
    s_add_u32 m0, s76, s99
    s_mul_i32 s101, s76, 28
    v_add_u32 v233, 27648, v233
    v_exp_f32 v156, v156
    v_exp_f32 v157, v157
    v_exp_f32 v158, v158
    v_exp_f32 v159, v159
    v_mfma_f32_32x32x16_bf16 v[128:143], a[208:211], v[40:43], 0
    buffer_load_dwordx4 v233, s[40:43], s101 offen offset:2048 lds
    v_exp_f32 v112, v112
    v_exp_f32 v113, v113
    v_exp_f32 v114, v114
    v_exp_f32 v115, v115
    v_mfma_f32_32x32x16_bf16 v[128:143], a[212:215], v[44:47], v[128:143]
    v_exp_f32 v116, v116
    v_exp_f32 v117, v117
    v_exp_f32 v118, v118
    v_exp_f32 v119, v119
    v_smfmac_f32_32x32x32_bf16 v[64:79], a[220:223], v[152:159], v5
    buffer_load_dwordx4 a[40:43], v3, s[32:35], s8 offen offset:0 sc1
    v_exp_f32 v120, v120
    v_exp_f32 v121, v121
    v_exp_f32 v122, v122
    v_exp_f32 v123, v123
    v_smfmac_f32_32x32x32_bf16 v[80:95], a[216:219], v[112:119], v5
    s_add_u32 m0, s77, s99
    s_mul_i32 s101, s77, 28
    v_exp_f32 v124, v124
    v_exp_f32 v125, v125
    v_exp_f32 v126, v126
    v_exp_f32 v127, v127
    v_mfma_f32_32x32x16_bf16 v[144:159], a[224:227], v[16:19], 0
    buffer_load_dwordx4 v233, s[40:43], s101 offen offset:2048 lds
    v_exp_f32 v128, v128
    v_exp_f32 v129, v129
    v_exp_f32 v130, v130
    v_exp_f32 v131, v131
    v_mfma_f32_32x32x16_bf16 v[144:159], a[228:231], v[20:23], v[144:159]
    v_exp_f32 v132, v132
    v_exp_f32 v133, v133
    v_exp_f32 v134, v134
    v_exp_f32 v135, v135
    v_smfmac_f32_32x32x32_bf16 v[80:95], a[220:223], v[120:127], v5
    buffer_load_dwordx4 a[44:47], v3, s[32:35], s8 offen offset:2048 sc1
    v_exp_f32 v136, v136
    v_exp_f32 v137, v137
    v_exp_f32 v138, v138
    v_exp_f32 v139, v139
    v_smfmac_f32_32x32x32_bf16 v[96:111], a[216:219], v[128:135], v5
    s_add_u32 s8, s8, 8192
    v_exp_f32 v140, v140
    v_exp_f32 v141, v141
    v_exp_f32 v142, v142
    v_exp_f32 v143, v143
    v_mfma_f32_32x32x16_bf16 v[112:127], a[224:227], v[24:27], 0
    buffer_load_dwordx4 a[48:51], v1, s[32:35], s8 offen offset:0 sc1
    v_exp_f32 v144, v144
    v_exp_f32 v145, v145
    v_exp_f32 v146, v146
    v_exp_f32 v147, v147
    v_mfma_f32_32x32x16_bf16 v[112:127], a[228:231], v[28:31], v[112:127]
    v_exp_f32 v148, v148
    v_exp_f32 v149, v149
    v_exp_f32 v150, v150
    v_exp_f32 v151, v151
    v_smfmac_f32_32x32x32_bf16 v[96:111], a[220:223], v[136:143], v5
    buffer_load_dwordx4 a[52:55], v1, s[32:35], s8 offen offset:2048 sc1
    v_exp_f32 v152, v152
    v_exp_f32 v153, v153
    v_exp_f32 v154, v154
    v_exp_f32 v155, v155
    v_smfmac_f32_32x32x32_bf16 v[48:63], a[232:235], v[144:151], v5
    s_add_u32 m0, s78, s99
    s_mul_i32 s101, s78, 28
    v_exp_f32 v156, v156
    v_exp_f32 v157, v157
    v_exp_f32 v158, v158
    v_exp_f32 v159, v159
    v_mfma_f32_32x32x16_bf16 v[128:143], a[224:227], v[32:35], 0
    buffer_load_dwordx4 v233, s[40:43], s101 offen offset:2048 lds
    v_exp_f32 v112, v112
    v_exp_f32 v113, v113
    v_exp_f32 v114, v114
    v_exp_f32 v115, v115
    v_mfma_f32_32x32x16_bf16 v[128:143], a[228:231], v[36:39], v[128:143]
    v_exp_f32 v116, v116
    v_exp_f32 v117, v117
    v_exp_f32 v118, v118
    v_exp_f32 v119, v119
    v_smfmac_f32_32x32x32_bf16 v[48:63], a[236:239], v[152:159], v5
    buffer_load_dwordx4 a[56:59], v3, s[32:35], s8 offen offset:0 sc1
    v_exp_f32 v120, v120
    v_exp_f32 v121, v121
    v_exp_f32 v122, v122
    v_exp_f32 v123, v123
    v_smfmac_f32_32x32x32_bf16 v[64:79], a[232:235], v[112:119], v5
    s_add_u32 m0, s79, s99
    s_mul_i32 s101, s79, 28
    v_exp_f32 v124, v124
    v_exp_f32 v125, v125
    v_exp_f32 v126, v126
    v_exp_f32 v127, v127
    v_mfma_f32_32x32x16_bf16 v[144:159], a[224:227], v[40:43], 0
    buffer_load_dwordx4 v233, s[40:43], s101 offen offset:2048 lds
    v_exp_f32 v128, v128
    v_exp_f32 v129, v129
    v_exp_f32 v130, v130
    v_exp_f32 v131, v131
    v_mfma_f32_32x32x16_bf16 v[144:159], a[228:231], v[44:47], v[144:159]
    v_exp_f32 v132, v132
    v_exp_f32 v133, v133
    v_exp_f32 v134, v134
    v_exp_f32 v135, v135
    v_smfmac_f32_32x32x32_bf16 v[64:79], a[236:239], v[120:127], v5
    buffer_load_dwordx4 a[60:63], v3, s[32:35], s8 offen offset:2048 sc1
    v_exp_f32 v136, v136
    v_exp_f32 v137, v137
    v_exp_f32 v138, v138
    v_exp_f32 v139, v139
    v_smfmac_f32_32x32x32_bf16 v[80:95], a[232:235], v[128:135], v5
    s_add_u32 m0, s80, s99
    s_mul_i32 s101, s80, 28
    v_exp_f32 v140, v140
    v_exp_f32 v141, v141
    v_exp_f32 v142, v142
    v_exp_f32 v143, v143
    v_mfma_f32_32x32x16_bf16 v[112:127], a[240:243], v[16:19], 0
    buffer_load_dwordx4 v233, s[40:43], s101 offen offset:2048 lds
    v_exp_f32 v144, v144
    v_exp_f32 v145, v145
    v_exp_f32 v146, v146
    v_exp_f32 v147, v147
    v_mfma_f32_32x32x16_bf16 v[112:127], a[244:247], v[20:23], v[112:127]
    s_add_u32 s8, s8, 8192
    v_exp_f32 v148, v148
    v_exp_f32 v149, v149
    v_exp_f32 v150, v150
    v_exp_f32 v151, v151
    v_smfmac_f32_32x32x32_bf16 v[80:95], a[236:239], v[136:143], v5
    buffer_load_dwordx4 a[64:67], v1, s[32:35], s8 offen offset:0 sc1
    v_exp_f32 v152, v152
    v_exp_f32 v153, v153
    v_exp_f32 v154, v154
    v_exp_f32 v155, v155
    v_smfmac_f32_32x32x32_bf16 v[96:111], a[232:235], v[144:151], v5
    v_exp_f32 v156, v156
    v_exp_f32 v157, v157
    v_exp_f32 v158, v158
    v_exp_f32 v159, v159
    v_mfma_f32_32x32x16_bf16 v[128:143], a[240:243], v[24:27], 0
    buffer_load_dwordx4 a[68:71], v1, s[32:35], s8 offen offset:2048 sc1
    v_exp_f32 v112, v112
    v_exp_f32 v113, v113
    v_exp_f32 v114, v114
    v_exp_f32 v115, v115
    v_mfma_f32_32x32x16_bf16 v[128:143], a[244:247], v[28:31], v[128:143]
    v_exp_f32 v116, v116
    v_exp_f32 v117, v117
    v_exp_f32 v118, v118
    v_exp_f32 v119, v119
    v_smfmac_f32_32x32x32_bf16 v[96:111], a[236:239], v[152:159], v5
    buffer_load_dwordx4 a[72:75], v3, s[32:35], s8 offen offset:0 sc1
    v_exp_f32 v120, v120
    v_exp_f32 v121, v121
    v_exp_f32 v122, v122
    v_exp_f32 v123, v123
    v_smfmac_f32_32x32x32_bf16 v[48:63], a[248:251], v[112:119], v5
    s_add_u32 m0, s81, s99
    s_mul_i32 s101, s81, 28
    v_exp_f32 v124, v124
    v_exp_f32 v125, v125
    v_exp_f32 v126, v126
    v_exp_f32 v127, v127
    v_mfma_f32_32x32x16_bf16 v[144:159], a[240:243], v[32:35], 0
    buffer_load_dwordx4 v233, s[40:43], s101 offen offset:2048 lds
    v_exp_f32 v128, v128
    v_exp_f32 v129, v129
    v_exp_f32 v130, v130
    v_exp_f32 v131, v131
    v_mfma_f32_32x32x16_bf16 v[144:159], a[244:247], v[36:39], v[144:159]
    v_exp_f32 v132, v132
    v_exp_f32 v133, v133
    v_exp_f32 v134, v134
    v_exp_f32 v135, v135
    v_smfmac_f32_32x32x32_bf16 v[48:63], a[252:255], v[120:127], v5
    buffer_load_dwordx4 a[76:79], v3, s[32:35], s8 offen offset:2048 sc1
    v_exp_f32 v136, v136
    v_exp_f32 v137, v137
    v_exp_f32 v138, v138
    v_exp_f32 v139, v139
    v_smfmac_f32_32x32x32_bf16 v[64:79], a[248:251], v[128:135], v5
    s_add_u32 m0, s82, s99
    s_mul_i32 s101, s82, 28
    v_exp_f32 v140, v140
    v_exp_f32 v141, v141
    v_exp_f32 v142, v142
    v_exp_f32 v143, v143
    v_mfma_f32_32x32x16_bf16 v[112:127], a[240:243], v[40:43], 0
    buffer_load_dwordx4 v233, s[40:43], s101 offen offset:2048 lds
    v_exp_f32 v144, v144
    v_exp_f32 v145, v145
    v_exp_f32 v146, v146
    v_exp_f32 v147, v147
    v_mfma_f32_32x32x16_bf16 v[112:127], a[244:247], v[44:47], v[112:127]
    s_add_u32 s8, s8, 8192
    v_exp_f32 v148, v148
    v_exp_f32 v149, v149
    v_exp_f32 v150, v150
    v_exp_f32 v151, v151
    v_smfmac_f32_32x32x32_bf16 v[64:79], a[252:255], v[136:143], v5
    buffer_load_dwordx4 a[80:83], v1, s[32:35], s8 offen offset:0 sc1
    v_exp_f32 v152, v152
    v_exp_f32 v153, v153
    v_exp_f32 v154, v154
    v_exp_f32 v155, v155
    v_smfmac_f32_32x32x32_bf16 v[80:95], a[248:251], v[144:151], v5
    s_add_u32 m0, s76, s99
    s_mul_i32 s101, s76, 28
    v_add_u32 v233, 27648, v233
    v_exp_f32 v156, v156
    v_exp_f32 v157, v157
    v_exp_f32 v158, v158
    v_exp_f32 v159, v159
    v_mfma_f32_32x32x16_bf16 v[128:143], v[160:163], v[16:19], 0
    buffer_load_dwordx4 v233, s[40:43], s101 offen offset:3072 lds
    v_exp_f32 v112, v112
    v_exp_f32 v113, v113
    v_exp_f32 v114, v114
    v_exp_f32 v115, v115
    v_mfma_f32_32x32x16_bf16 v[128:143], v[164:167], v[20:23], v[128:143]
    v_exp_f32 v116, v116
    v_exp_f32 v117, v117
    v_exp_f32 v118, v118
    v_exp_f32 v119, v119
    v_smfmac_f32_32x32x32_bf16 v[80:95], a[252:255], v[152:159], v5
    buffer_load_dwordx4 a[84:87], v1, s[32:35], s8 offen offset:2048 sc1
    v_exp_f32 v120, v120
    v_exp_f32 v121, v121
    v_exp_f32 v122, v122
    v_exp_f32 v123, v123
    v_smfmac_f32_32x32x32_bf16 v[96:111], a[248:251], v[112:119], v5
    v_exp_f32 v124, v124
    v_exp_f32 v125, v125
    v_exp_f32 v126, v126
    v_exp_f32 v127, v127
    v_mfma_f32_32x32x16_bf16 v[144:159], v[160:163], v[24:27], 0
    buffer_load_dwordx4 a[88:91], v3, s[32:35], s8 offen offset:0 sc1
    v_exp_f32 v128, v128
    v_exp_f32 v129, v129
    v_exp_f32 v130, v130
    v_exp_f32 v131, v131
    v_mfma_f32_32x32x16_bf16 v[144:159], v[164:167], v[28:31], v[144:159]
    v_exp_f32 v132, v132
    v_exp_f32 v133, v133
    v_exp_f32 v134, v134
    v_exp_f32 v135, v135
    v_smfmac_f32_32x32x32_bf16 v[96:111], a[252:255], v[120:127], v5
    buffer_load_dwordx4 a[92:95], v3, s[32:35], s8 offen offset:2048 sc1
    v_exp_f32 v136, v136
    v_exp_f32 v137, v137
    v_exp_f32 v138, v138
    v_exp_f32 v139, v139
    v_smfmac_f32_32x32x32_bf16 v[48:63], v[168:171], v[128:135], v5
    s_getpc_b64 s[84:85]
L_pc2:
    s_lshl_b32 s72, s65, 2
    s_add_u32 s72, s72, s61
    s_lshl_b32 s72, s72, 8
    v_and_b32 v227, 128, v1
    v_add_u32 v227, s72, v227
    v_min_u32 v227, L_exit-L_pc2, v227
    global_load_dword v226, v227, s[84:85]
    s_add_u32 m0, s77, s99
    s_mul_i32 s101, s77, 28
    v_exp_f32 v140, v140
    v_exp_f32 v141, v141
    v_exp_f32 v142, v142
    v_exp_f32 v143, v143
    v_mfma_f32_32x32x16_bf16 v[112:127], v[160:163], v[32:35], 0
    buffer_load_dwordx4 v233, s[40:43], s101 offen offset:3072 lds
    v_exp_f32 v144, v144
    v_exp_f32 v145, v145
    v_exp_f32 v146, v146
    v_exp_f32 v147, v147
    v_mfma_f32_32x32x16_bf16 v[112:127], v[164:167], v[36:39], v[112:127]
    buffer_load_dword v226, v232, s[24:27], 0 offen sc1
    s_add_u32 s8, s8, 8192
    v_exp_f32 v148, v148
    v_exp_f32 v149, v149
    v_exp_f32 v150, v150
    v_exp_f32 v151, v151
    v_smfmac_f32_32x32x32_bf16 v[48:63], v[172:175], v[136:143], v5
    buffer_load_dwordx4 a[96:99], v1, s[32:35], s8 offen offset:0 sc1
    v_exp_f32 v152, v152
    v_exp_f32 v153, v153
    v_exp_f32 v154, v154
    v_exp_f32 v155, v155
    v_smfmac_f32_32x32x32_bf16 v[64:79], v[168:171], v[144:151], v5
    s_add_u32 m0, s78, s99
    s_mul_i32 s101, s78, 28
    v_exp_f32 v156, v156
    v_exp_f32 v157, v157
    v_exp_f32 v158, v158
    v_exp_f32 v159, v159
    v_mfma_f32_32x32x16_bf16 v[128:143], v[160:163], v[40:43], 0
    buffer_load_dwordx4 v233, s[40:43], s101 offen offset:3072 lds
    v_exp_f32 v112, v112
    v_exp_f32 v113, v113
    v_exp_f32 v114, v114
    v_exp_f32 v115, v115
    v_mfma_f32_32x32x16_bf16 v[128:143], v[164:167], v[44:47], v[128:143]
    v_exp_f32 v116, v116
    v_exp_f32 v117, v117
    v_exp_f32 v118, v118
    v_exp_f32 v119, v119
    v_smfmac_f32_32x32x32_bf16 v[64:79], v[172:175], v[152:159], v5
    buffer_load_dwordx4 a[100:103], v1, s[32:35], s8 offen offset:2048 sc1
    v_exp_f32 v120, v120
    v_exp_f32 v121, v121
    v_exp_f32 v122, v122
    v_exp_f32 v123, v123
    v_smfmac_f32_32x32x32_bf16 v[80:95], v[168:171], v[112:119], v5
    s_waitcnt vmcnt(50)
    s_add_u32 m0, s79, s99
    s_mul_i32 s101, s79, 28
    v_exp_f32 v124, v124
    v_exp_f32 v125, v125
    v_exp_f32 v126, v126
    v_exp_f32 v127, v127
    v_mfma_f32_32x32x16_bf16 v[144:159], v[176:179], v[16:19], 0
    buffer_load_dwordx4 v233, s[40:43], s101 offen offset:3072 lds
    v_exp_f32 v128, v128
    v_exp_f32 v129, v129
    v_exp_f32 v130, v130
    v_exp_f32 v131, v131
    v_mfma_f32_32x32x16_bf16 v[144:159], v[180:183], v[20:23], v[144:159]
    v_exp_f32 v132, v132
    v_exp_f32 v133, v133
    v_exp_f32 v134, v134
    v_exp_f32 v135, v135
    v_smfmac_f32_32x32x32_bf16 v[80:95], v[172:175], v[120:127], v5
    buffer_load_dwordx4 a[104:107], v3, s[32:35], s8 offen offset:0 sc1
    v_exp_f32 v136, v136
    v_exp_f32 v137, v137
    v_exp_f32 v138, v138
    v_exp_f32 v139, v139
    v_smfmac_f32_32x32x32_bf16 v[96:111], v[168:171], v[128:135], v5
    v_exp_f32 v140, v140
    v_exp_f32 v141, v141
    v_exp_f32 v142, v142
    v_exp_f32 v143, v143
    v_mfma_f32_32x32x16_bf16 v[112:127], v[176:179], v[24:27], 0
    buffer_load_dwordx4 a[108:111], v3, s[32:35], s8 offen offset:2048 sc1
    v_exp_f32 v144, v144
    v_exp_f32 v145, v145
    v_exp_f32 v146, v146
    v_exp_f32 v147, v147
    v_mfma_f32_32x32x16_bf16 v[112:127], v[180:183], v[28:31], v[112:127]
    v_exp_f32 v148, v148
    v_exp_f32 v149, v149
    v_exp_f32 v150, v150
    v_exp_f32 v151, v151
    v_smfmac_f32_32x32x32_bf16 v[96:111], v[172:175], v[136:143], v5
    buffer_load_dwordx4 a[112:115], v6, s[44:47], s21 offen offset:0 sc1
    v_exp_f32 v152, v152
    v_exp_f32 v153, v153
    v_exp_f32 v154, v154
    v_exp_f32 v155, v155
    v_smfmac_f32_32x32x32_bf16 v[48:63], v[184:187], v[144:151], v5
    s_add_u32 m0, s80, s99
    s_mul_i32 s101, s80, 28
    v_exp_f32 v156, v156
    v_exp_f32 v157, v157
    v_exp_f32 v158, v158
    v_exp_f32 v159, v159
    v_mfma_f32_32x32x16_bf16 v[128:143], v[176:179], v[32:35], 0
    buffer_load_dwordx4 v233, s[40:43], s101 offen offset:3072 lds
    v_exp_f32 v112, v112
    v_exp_f32 v113, v113
    v_exp_f32 v114, v114
    v_exp_f32 v115, v115
    v_mfma_f32_32x32x16_bf16 v[128:143], v[180:183], v[36:39], v[128:143]
    v_exp_f32 v116, v116
    v_exp_f32 v117, v117
    v_exp_f32 v118, v118
    v_exp_f32 v119, v119
    v_smfmac_f32_32x32x32_bf16 v[48:63], v[188:191], v[152:159], v5
    buffer_load_dwordx4 a[116:119], v7, s[44:47], s21 offen offset:0 sc1
    v_exp_f32 v120, v120
    v_exp_f32 v121, v121
    v_exp_f32 v122, v122
    v_exp_f32 v123, v123
    v_smfmac_f32_32x32x32_bf16 v[64:79], v[184:187], v[112:119], v5
    s_add_u32 m0, s81, s99
    s_mul_i32 s101, s81, 28
    v_exp_f32 v124, v124
    v_exp_f32 v125, v125
    v_exp_f32 v126, v126
    v_exp_f32 v127, v127
    v_mfma_f32_32x32x16_bf16 v[144:159], v[176:179], v[40:43], 0
    buffer_load_dwordx4 v233, s[40:43], s101 offen offset:3072 lds
    v_exp_f32 v128, v128
    v_exp_f32 v129, v129
    v_exp_f32 v130, v130
    v_exp_f32 v131, v131
    v_mfma_f32_32x32x16_bf16 v[144:159], v[180:183], v[44:47], v[144:159]
    s_add_u32 s21, s21, 8192
    v_exp_f32 v132, v132
    v_exp_f32 v133, v133
    v_exp_f32 v134, v134
    v_exp_f32 v135, v135
    v_smfmac_f32_32x32x32_bf16 v[64:79], v[188:191], v[120:127], v5
    buffer_load_dwordx4 a[120:123], v6, s[44:47], s21 offen offset:0 sc1
    v_exp_f32 v136, v136
    v_exp_f32 v137, v137
    v_exp_f32 v138, v138
    v_exp_f32 v139, v139
    v_smfmac_f32_32x32x32_bf16 v[80:95], v[184:187], v[128:135], v5
    s_waitcnt vmcnt(52)
    s_add_u32 m0, s82, s99
    s_mul_i32 s101, s82, 28
    v_exp_f32 v140, v140
    v_exp_f32 v141, v141
    v_exp_f32 v142, v142
    v_exp_f32 v143, v143
    v_mfma_f32_32x32x16_bf16 v[112:127], v[192:195], v[16:19], 0
    buffer_load_dwordx4 v233, s[40:43], s101 offen offset:3072 lds
    v_exp_f32 v144, v144
    v_exp_f32 v145, v145
    v_exp_f32 v146, v146
    v_exp_f32 v147, v147
    v_mfma_f32_32x32x16_bf16 v[112:127], v[196:199], v[20:23], v[112:127]
    v_exp_f32 v148, v148
    v_exp_f32 v149, v149
    v_exp_f32 v150, v150
    v_exp_f32 v151, v151
    v_smfmac_f32_32x32x32_bf16 v[80:95], v[188:191], v[136:143], v5
    buffer_load_dwordx4 a[124:127], v7, s[44:47], s21 offen offset:0 sc1
    v_exp_f32 v152, v152
    v_exp_f32 v153, v153
    v_exp_f32 v154, v154
    v_exp_f32 v155, v155
    v_smfmac_f32_32x32x32_bf16 v[96:111], v[184:187], v[144:151], v5
    s_add_u32 s21, s21, 8192
    v_exp_f32 v156, v156
    v_exp_f32 v157, v157
    v_exp_f32 v158, v158
    v_exp_f32 v159, v159
    v_mfma_f32_32x32x16_bf16 v[128:143], v[192:195], v[24:27], 0
    buffer_load_dwordx4 a[128:131], v6, s[44:47], s21 offen offset:0 sc1
    v_exp_f32 v112, v112
    v_exp_f32 v113, v113
    v_exp_f32 v114, v114
    v_exp_f32 v115, v115
    v_mfma_f32_32x32x16_bf16 v[128:143], v[196:199], v[28:31], v[128:143]
    v_exp_f32 v116, v116
    v_exp_f32 v117, v117
    v_exp_f32 v118, v118
    v_exp_f32 v119, v119
    v_smfmac_f32_32x32x32_bf16 v[96:111], v[188:191], v[152:159], v5
    buffer_load_dwordx4 a[132:135], v7, s[44:47], s21 offen offset:0 sc1
    v_exp_f32 v120, v120
    v_exp_f32 v121, v121
    v_exp_f32 v122, v122
    v_exp_f32 v123, v123
    v_smfmac_f32_32x32x32_bf16 v[48:63], v[200:203], v[112:119], v5
    s_add_u32 s21, s21, 8192
    v_exp_f32 v124, v124
    v_exp_f32 v125, v125
    v_exp_f32 v126, v126
    v_exp_f32 v127, v127
    v_mfma_f32_32x32x16_bf16 v[144:159], v[192:195], v[32:35], 0
    buffer_load_dwordx4 a[136:139], v6, s[44:47], s21 offen offset:0 sc1
    v_exp_f32 v128, v128
    v_exp_f32 v129, v129
    v_exp_f32 v130, v130
    v_exp_f32 v131, v131
    v_mfma_f32_32x32x16_bf16 v[144:159], v[196:199], v[36:39], v[144:159]
    v_exp_f32 v132, v132
    v_exp_f32 v133, v133
    v_exp_f32 v134, v134
    v_exp_f32 v135, v135
    v_smfmac_f32_32x32x32_bf16 v[48:63], v[204:207], v[120:127], v5
    buffer_load_dwordx4 a[140:143], v7, s[44:47], s21 offen offset:0 sc1
    v_exp_f32 v136, v136
    v_exp_f32 v137, v137
    v_exp_f32 v138, v138
    v_exp_f32 v139, v139
    v_smfmac_f32_32x32x32_bf16 v[64:79], v[200:203], v[128:135], v5
    s_add_u32 s21, s21, 8192
    v_exp_f32 v140, v140
    v_exp_f32 v141, v141
    v_exp_f32 v142, v142
    v_exp_f32 v143, v143
    v_mfma_f32_32x32x16_bf16 v[112:127], v[192:195], v[40:43], 0
    buffer_load_dwordx4 a[144:147], v6, s[44:47], s21 offen offset:0 sc1
    v_exp_f32 v144, v144
    v_exp_f32 v145, v145
    v_exp_f32 v146, v146
    v_exp_f32 v147, v147
    v_mfma_f32_32x32x16_bf16 v[112:127], v[196:199], v[44:47], v[112:127]
    ds_write_b128 v240, v[48:51] offset:0
    v_exp_f32 v148, v148
    v_exp_f32 v149, v149
    v_exp_f32 v150, v150
    v_exp_f32 v151, v151
    v_smfmac_f32_32x32x32_bf16 v[64:79], v[204:207], v[136:143], v5
    ds_write_b128 v240, v[52:55] offset:1024
    v_exp_f32 v152, v152
    v_exp_f32 v153, v153
    v_exp_f32 v154, v154
    v_exp_f32 v155, v155
    v_smfmac_f32_32x32x32_bf16 v[80:95], v[200:203], v[144:151], v5
    ds_write_b128 v240, v[56:59] offset:2048
    v_exp_f32 v156, v156
    v_exp_f32 v157, v157
    v_exp_f32 v158, v158
    v_exp_f32 v159, v159
    ds_write_b128 v240, v[60:63] offset:3072
    v_exp_f32 v112, v112
    v_exp_f32 v113, v113
    v_exp_f32 v114, v114
    v_exp_f32 v115, v115
    v_smfmac_f32_32x32x32_bf16 v[80:95], v[204:207], v[152:159], v5
    ds_write_b128 v241, v[64:67] offset:0
    v_exp_f32 v116, v116
    v_exp_f32 v117, v117
    v_exp_f32 v118, v118
    v_exp_f32 v119, v119
    ds_write_b128 v241, v[68:71] offset:1024
    v_exp_f32 v120, v120
    v_exp_f32 v121, v121
    v_exp_f32 v122, v122
    v_exp_f32 v123, v123
    v_smfmac_f32_32x32x32_bf16 v[96:111], v[200:203], v[112:119], v5
    ds_write_b128 v241, v[72:75] offset:2048
    v_exp_f32 v124, v124
    v_exp_f32 v125, v125
    v_exp_f32 v126, v126
    v_exp_f32 v127, v127
    ds_write_b128 v241, v[76:79] offset:3072
    ds_write_b128 v242, v[80:83] offset:0
    v_smfmac_f32_32x32x32_bf16 v[96:111], v[204:207], v[120:127], v5
    ds_write_b128 v242, v[84:87] offset:1024
    ds_write_b128 v242, v[88:91] offset:2048
    ds_write_b128 v242, v[92:95] offset:3072
    s_waitcnt vmcnt(6)
    s_waitcnt lgkmcnt(0)
    s_barrier
    ds_read_b128 v[60:63], v243 offset:3072
    ds_read_b128 v[76:79], v243 offset:7168
    ds_read_b128 v[92:95], v243 offset:11264
    ds_read_b128 v[48:51], v243 offset:0
    ds_read_b128 v[64:67], v243 offset:4096
    ds_read_b128 v[80:83], v243 offset:8192
    ds_read_b128 v[52:55], v243 offset:1024
    ds_read_b128 v[68:71], v243 offset:5120
    ds_read_b128 v[84:87], v243 offset:9216
    ds_read_b128 v[56:59], v243 offset:2048
    ds_read_b128 v[72:75], v243 offset:6144
    ds_read_b128 v[88:91], v243 offset:10240
    s_mov_b32 s72, 0x2b800000
    s_mov_b32 s73, 0x53800000
    s_waitcnt lgkmcnt(10)
    v_pk_add_f32 v[108:109], v[108:109], v[60:61]
    v_pk_add_f32 v[110:111], v[110:111], v[62:63]
    v_pk_add_f32 v[108:109], v[108:109], v[76:77]
    v_pk_add_f32 v[110:111], v[110:111], v[78:79]
    s_waitcnt lgkmcnt(9)
    v_pk_add_f32 v[108:109], v[108:109], v[92:93]
    v_pk_add_f32 v[110:111], v[110:111], v[94:95]
    v_mov_b32 v156, v108
    v_mov_b32 v157, v108
    s_waitcnt lgkmcnt(7)
    v_pk_add_f32 v[96:97], v[96:97], v[48:49]
    v_pk_add_f32 v[98:99], v[98:99], v[50:51]
    v_permlane32_swap_b32 v156, v157
L_hop_2:
    s_cbranch_execz L_hop_3
    v_pk_add_f32 v[96:97], v[96:97], v[64:65]
    v_pk_add_f32 v[98:99], v[98:99], v[66:67]
    v_rcp_f32 v156, v157
    v_cmp_nle_f32 vcc, s72, v157
    v_cmp_nge_f32 s[92:93], s73, v157
    s_waitcnt lgkmcnt(6)
    v_pk_add_f32 v[96:97], v[96:97], v[80:81]
    v_pk_add_f32 v[98:99], v[98:99], v[82:83]
    v_pk_mul_f32 v[108:109], v[108:109], v[156:157] op_sel_hi:[1,0]
    v_pk_mul_f32 v[110:111], v[110:111], v[156:157] op_sel_hi:[1,0]
    v_cvt_pk_bf16_f32 v150, v108, v109
    v_cvt_pk_bf16_f32 v151, v110, v111
    v_pk_mul_f32 v[96:97], v[96:97], v[156:157] op_sel_hi:[1,0]
    v_pk_mul_f32 v[98:99], v[98:99], v[156:157] op_sel_hi:[1,0]
    v_cvt_pk_bf16_f32 v144, v96, v97
    v_cvt_pk_bf16_f32 v145, v98, v99
    s_waitcnt lgkmcnt(4)
    v_pk_add_f32 v[100:101], v[100:101], v[52:53]
    v_pk_add_f32 v[102:103], v[102:103], v[54:55]
    v_pk_add_f32 v[100:101], v[100:101], v[68:69]
    v_pk_add_f32 v[102:103], v[102:103], v[70:71]
    s_waitcnt lgkmcnt(3)
    v_pk_add_f32 v[100:101], v[100:101], v[84:85]
    v_pk_add_f32 v[102:103], v[102:103], v[86:87]
    v_pk_mul_f32 v[100:101], v[100:101], v[156:157] op_sel_hi:[1,0]
    v_pk_mul_f32 v[102:103], v[102:103], v[156:157] op_sel_hi:[1,0]
    v_cvt_pk_bf16_f32 v146, v100, v101
    v_cvt_pk_bf16_f32 v147, v102, v103
    s_waitcnt lgkmcnt(1)
    v_pk_add_f32 v[104:105], v[104:105], v[56:57]
    v_pk_add_f32 v[106:107], v[106:107], v[58:59]
    v_pk_add_f32 v[104:105], v[104:105], v[72:73]
    v_pk_add_f32 v[106:107], v[106:107], v[74:75]
    s_waitcnt lgkmcnt(0)
    v_pk_add_f32 v[104:105], v[104:105], v[88:89]
    v_pk_add_f32 v[106:107], v[106:107], v[90:91]
    v_pk_mul_f32 v[104:105], v[104:105], v[156:157] op_sel_hi:[1,0]
    v_pk_mul_f32 v[106:107], v[106:107], v[156:157] op_sel_hi:[1,0]
    v_cvt_pk_bf16_f32 v148, v104, v105
    v_cvt_pk_bf16_f32 v149, v106, v107
    s_cmp_eq_u32 s3, 0
    s_cbranch_scc1 L_far_12
    buffer_store_dwordx2 v[144:145], v244, s[24:27], s9 offen offset:0
    buffer_store_dwordx2 v[146:147], v244, s[24:27], s9 offen offset:128
    buffer_store_dwordx2 v[148:149], v244, s[24:27], s9 offen offset:256
    s_mov_b32 exec_hi, 0
    buffer_store_dwordx2 v[150:151], v244, s[24:27], s9 offen offset:384
L_back_13:
    s_or_b64 vcc, vcc, s[92:93]
    s_cselect_b32 s73, 1, 0
    v_mov_b32 v157, s73
    s_mov_b32 exec_lo, 1
    ds_write_b32 v243, v157 offset:12032
    s_mov_b64 exec, -1
    s_waitcnt lgkmcnt(0)
    s_barrier
    ds_read_b32 v157, v245
    ds_read_b64_tr_b16 v[80:81], v249 offset:0
    ds_read_b64_tr_b16 v[82:83], v249 offset:512
    ds_read_b64_tr_b16 v[84:85], v249 offset:2048
    ds_read_b64_tr_b16 v[86:87], v249 offset:2560
    ds_read_b64_tr_b16 v[88:89], v249 offset:4096
    ds_read_b64_tr_b16 v[90:91], v249 offset:4608
    ds_read_b64_tr_b16 v[92:93], v249 offset:6144
    ds_read_b64_tr_b16 v[94:95], v249 offset:6656
    v_mov_b32 v220, 0x3f803f80
    v_mov_b32 v221, 0x3f803f80
    v_mov_b32 v222, 0x3f803f80
    v_mov_b32 v223, 0x3f803f80
    s_waitcnt lgkmcnt(8)
    v_cmp_ne_u32 vcc, 0, v157
    s_cmp_lg_u32 s69, 0
    s_cselect_b64 vcc, 0, vcc
    s_cbranch_vccnz L_redo
    s_cmp_eq_u32 s3, 0
    s_cselect_b64 vcc, -1, 0
    s_waitcnt vmcnt(0)
    s_cbranch_vccnz L_far_14
    buffer_store_dword v4, v2, s[24:27], s10 offen
L_back_15:
    s_mov_b32 m0, s12
    s_waitcnt lgkmcnt(6)
    v_mfma_f32_32x32x16_bf16 v[192:207], v[220:223], v[80:83], 0
    ds_read_b64_tr_b16 v[80:81], v249 offset:8192
    ds_read_b64_tr_b16 v[82:83], v249 offset:8704
    s_waitcnt lgkmcnt(6)
    v_mfma_f32_32x32x16_bf16 v[192:207], v[220:223], v[84:87], v[192:207]
    ds_read_b64_tr_b16 v[84:85], v249 offset:10240
    ds_read_b64_tr_b16 v[86:87], v249 offset:10752
    s_waitcnt lgkmcnt(6)
    v_mfma_f32_32x32x16_bf16 v[192:207], v[220:223], v[88:91], v[192:207]
    ds_read_b64_tr_b16 v[88:89], v249 offset:12288
    ds_read_b64_tr_b16 v[90:91], v249 offset:12800
    s_waitcnt lgkmcnt(6)
    v_mfma_f32_32x32x16_bf16 v[192:207], v[220:223], v[92:95], v[192:207]
    ds_read_b64_tr_b16 v[92:93], v249 offset:14336
    ds_read_b64_tr_b16 v[94:95], v249 offset:14848
    s_waitcnt lgkmcnt(6)
    v_mfma_f32_32x32x16_bf16 v[192:207], v[220:223], v[80:83], v[192:207]
    ds_read_b64_tr_b16 v[80:81], v249 offset:16384
    ds_read_b64_tr_b16 v[82:83], v249 offset:16896
    buffer_load_dword v224, v246, s[24:27], 0 offen sc1
    s_waitcnt lgkmcnt(6)
    v_mfma_f32_32x32x16_bf16 v[192:207], v[220:223], v[84:87], v[192:207]
    ds_read_b64_tr_b16 v[84:85], v249 offset:18432
    ds_read_b64_tr_b16 v[86:87], v249 offset:18944
    s_waitcnt lgkmcnt(6)
    v_mfma_f32_32x32x16_bf16 v[192:207], v[220:223], v[88:91], v[192:207]
    ds_read_b64_tr_b16 v[88:89], v249 offset:20480
    ds_read_b64_tr_b16 v[90:91], v249 offset:20992
    s_waitcnt lgkmcnt(6)
    v_mfma_f32_32x32x16_bf16 v[192:207], v[220:223], v[92:95], v[192:207]
    ds_read_b64_tr_b16 v[92:93], v249 offset:22528
    ds_read_b64_tr_b16 v[94:95], v249 offset:23040
    s_waitcnt lgkmcnt(6)
    v_mfma_f32_32x32x16_bf16 v[192:207], v[220:223], v[80:83], v[192:207]
    ds_read_b64_tr_b16 v[80:81], v249 offset:24576
    ds_read_b64_tr_b16 v[82:83], v249 offset:25088
    s_waitcnt lgkmcnt(6)
    v_mfma_f32_32x32x16_bf16 v[192:207], v[220:223], v[84:87], v[192:207]
    ds_read_b64_tr_b16 v[84:85], v249 offset:26624
    ds_read_b64_tr_b16 v[86:87], v249 offset:27136
    s_waitcnt vmcnt(0)
    v_cmp_ne_u32 s[92:93], s66, v224
    s_cmp_lg_u64 s[92:93], 0
    s_cbranch_scc1 L_x2a_spin_16
L_x2a_ok_17:
    buffer_load_dwordx4 v1, s[24:27], s11 offen offset:0 sc1 lds
    buffer_load_dwordx4 v1, s[24:27], s11 offen offset:1024 sc1 lds
    s_mov_b32 s73, 0xffff0000
    v_lshlrev_b32 v112, 16, v208
    v_and_b32 v113, s73, v208
    v_lshlrev_b32 v114, 16, v209
    v_and_b32 v115, s73, v209
    v_lshlrev_b32 v116, 16, v210
    v_and_b32 v117, s73, v210
    v_lshlrev_b32 v118, 16, v211
    v_and_b32 v119, s73, v211
    v_lshlrev_b32 v120, 16, v212
    v_and_b32 v121, s73, v212
    v_lshlrev_b32 v122, 16, v213
    v_and_b32 v123, s73, v213
    v_lshlrev_b32 v124, 16, v214
    v_and_b32 v125, s73, v214
    v_lshlrev_b32 v126, 16, v215
    v_and_b32 v127, s73, v215
    buffer_load_dwordx4 v1, s[24:27], s11 offen offset:2048 sc1 lds
    buffer_load_dwordx4 v1, s[24:27], s11 offen offset:3072 sc1 lds
    s_add_u32 m0, s12, 4096
    s_add_u32 s11, s11, 4096
    buffer_load_dwordx4 v1, s[24:27], s11 offen offset:0 sc1 lds
    buffer_load_dwordx4 v1, s[24:27], s11 offen offset:1024 sc1 lds
    buffer_load_dwordx4 v1, s[24:27], s11 offen offset:2048 sc1 lds
    s_waitcnt lgkmcnt(6)
    v_mfma_f32_32x32x16_bf16 v[192:207], v[220:223], v[88:91], v[192:207]
    ds_read_b64_tr_b16 v[88:89], v249 offset:28672
    ds_read_b64_tr_b16 v[90:91], v249 offset:29184
    s_waitcnt lgkmcnt(6)
    v_mfma_f32_32x32x16_bf16 v[192:207], v[220:223], v[92:95], v[192:207]
    ds_read_b64_tr_b16 v[92:93], v249 offset:30720
    ds_read_b64_tr_b16 v[94:95], v249 offset:31232
    s_waitcnt lgkmcnt(6)
    v_mfma_f32_32x32x16_bf16 v[192:207], v[220:223], v[80:83], v[192:207]
    ds_read_b64_tr_b16 v[80:81], v249 offset:32768
    ds_read_b64_tr_b16 v[82:83], v249 offset:33280
    s_waitcnt lgkmcnt(6)
    v_mfma_f32_32x32x16_bf16 v[192:207], v[220:223], v[84:87], v[192:207]
    ds_read_b64_tr_b16 v[84:85], v249 offset:34816
    ds_read_b64_tr_b16 v[86:87], v249 offset:35328
    s_waitcnt vmcnt(5)
    s_barrier
    ds_read_b128 v[128:131], v247 offset:0
    ds_read_b128 v[132:135], v247 offset:256
    ds_read_b128 v[136:139], v247 offset:512
    ds_read_b128 v[140:143], v247 offset:768
    ds_read_b128 v[144:147], v247 offset:1024
    s_waitcnt lgkmcnt(4)
    v_mfma_f32_32x32x16_bf16 v[112:127], a[0:3], v[128:131], v[112:127]
    s_waitcnt lgkmcnt(3)
    ds_read_b128 v[148:151], v247 offset:1280
    buffer_load_dwordx4 a[148:151], v7, s[44:47], s21 offen offset:0 sc1
    v_mfma_f32_32x32x16_bf16 v[112:127], a[4:7], v[132:135], v[112:127]
    s_waitcnt lgkmcnt(3)
    ds_read_b128 v[128:131], v247 offset:1536
    v_mfma_f32_32x32x16_bf16 v[112:127], a[8:11], v[136:139], v[112:127]
    s_waitcnt lgkmcnt(3)
    ds_read_b128 v[132:135], v247 offset:1792
    s_add_u32 s21, s21, 8192
    buffer_load_dwordx4 a[152:155], v6, s[44:47], s21 offen offset:0 sc1
    v_mfma_f32_32x32x16_bf16 v[112:127], a[12:15], v[140:143], v[112:127]
    s_waitcnt lgkmcnt(3)
    s_waitcnt vmcnt(2)
    s_barrier
    s_cbranch_vccnz L_far_18
    buffer_store_dword v4, v2, s[52:55], s5 offen offset:640
L_back_19:
    ds_read_b128 v[136:139], v247 offset:2048
    v_mfma_f32_32x32x16_bf16 v[112:127], a[16:19], v[144:147], v[112:127]
    s_waitcnt lgkmcnt(3)
    ds_read_b128 v[140:143], v247 offset:2304
    buffer_load_dwordx4 a[156:159], v7, s[44:47], s21 offen offset:0 sc1
    v_mfma_f32_32x32x16_bf16 v[112:127], a[20:23], v[148:151], v[112:127]
    s_waitcnt lgkmcnt(3)
    ds_read_b128 v[144:147], v247 offset:2560
    v_mfma_f32_32x32x16_bf16 v[112:127], a[24:27], v[128:131], v[112:127]
    s_waitcnt lgkmcnt(3)
    ds_read_b128 v[148:151], v247 offset:2816
    s_add_u32 s21, s21, 8192
    buffer_load_dwordx4 a[160:163], v6, s[44:47], s21 offen offset:0 sc1
    v_mfma_f32_32x32x16_bf16 v[112:127], a[28:31], v[132:135], v[112:127]
    s_waitcnt lgkmcnt(3)
    ds_read_b128 v[128:131], v247 offset:3072
    v_mfma_f32_32x32x16_bf16 v[112:127], a[32:35], v[136:139], v[112:127]
    s_waitcnt lgkmcnt(3)
    ds_read_b128 v[132:135], v247 offset:3328
    buffer_load_dwordx4 a[164:167], v7, s[44:47], s21 offen offset:0 sc1
    v_mfma_f32_32x32x16_bf16 v[112:127], a[36:39], v[140:143], v[112:127]
    s_waitcnt lgkmcnt(3)
    ds_read_b128 v[136:139], v247 offset:3584
    v_mfma_f32_32x32x16_bf16 v[112:127], a[40:43], v[144:147], v[112:127]
    s_waitcnt lgkmcnt(3)
    ds_read_b128 v[140:143], v247 offset:3840
    s_add_u32 s21, s21, 4294918144
    buffer_load_dwordx4 a[168:171], v6, s[44:47], s21 offen offset:2048 sc1
    v_mfma_f32_32x32x16_bf16 v[112:127], a[44:47], v[148:151], v[112:127]
    s_waitcnt lgkmcnt(3)
    ds_read_b128 v[144:147], v247 offset:4096
    v_mfma_f32_32x32x16_bf16 v[112:127], a[48:51], v[128:131], v[112:127]
    s_waitcnt lgkmcnt(3)
    ds_read_b128 v[148:151], v247 offset:4352
    v_mfma_f32_32x32x16_bf16 v[112:127], a[52:55], v[132:135], v[112:127]
    s_waitcnt lgkmcnt(3)
    ds_read_b128 v[128:131], v247 offset:4608
    v_mfma_f32_32x32x16_bf16 v[112:127], a[56:59], v[136:139], v[112:127]
    s_waitcnt lgkmcnt(3)
    ds_read_b128 v[132:135], v247 offset:4864
    buffer_load_dword v224, v252, s[24:27], 0 offen offset:640 sc1
    v_mfma_f32_32x32x16_bf16 v[112:127], a[60:63], v[140:143], v[112:127]
    s_waitcnt lgkmcnt(3)
    ds_read_b128 v[136:139], v247 offset:5120
    v_mfma_f32_32x32x16_bf16 v[112:127], a[64:67], v[144:147], v[112:127]
    s_waitcnt lgkmcnt(3)
    ds_read_b128 v[140:143], v247 offset:5376
    v_mfma_f32_32x32x16_bf16 v[112:127], a[68:71], v[148:151], v[112:127]
    s_waitcnt lgkmcnt(3)
    ds_read_b128 v[144:147], v247 offset:5632
    v_mfma_f32_32x32x16_bf16 v[112:127], a[72:75], v[128:131], v[112:127]
    s_waitcnt lgkmcnt(3)
    ds_read_b128 v[148:151], v247 offset:5888
    v_mfma_f32_32x32x16_bf16 v[112:127], a[76:79], v[132:135], v[112:127]
    s_waitcnt lgkmcnt(3)
    ds_read_b128 v[128:131], v247 offset:6144
    v_mfma_f32_32x32x16_bf16 v[112:127], a[80:83], v[136:139], v[112:127]
    s_waitcnt lgkmcnt(3)
    ds_read_b128 v[132:135], v247 offset:6400
    v_mfma_f32_32x32x16_bf16 v[112:127], a[84:87], v[140:143], v[112:127]
    s_waitcnt lgkmcnt(3)
    ds_read_b128 v[136:139], v247 offset:6656
    v_mfma_f32_32x32x16_bf16 v[112:127], a[88:91], v[144:147], v[112:127]
    s_waitcnt lgkmcnt(3)
    ds_read_b128 v[140:143], v247 offset:6912
    v_mfma_f32_32x32x16_bf16 v[112:127], a[92:95], v[148:151], v[112:127]
    s_waitcnt lgkmcnt(3)
    v_mfma_f32_32x32x16_bf16 v[112:127], a[96:99], v[128:131], v[112:127]
    s_waitcnt lgkmcnt(2)
    v_mfma_f32_32x32x16_bf16 v[112:127], a[100:103], v[132:135], v[112:127]
    s_waitcnt lgkmcnt(1)
    v_mfma_f32_32x32x16_bf16 v[112:127], a[104:107], v[136:139], v[112:127]
    s_waitcnt lgkmcnt(0)
    v_mfma_f32_32x32x16_bf16 v[112:127], a[108:111], v[140:143], v[112:127]
    s_waitcnt vmcnt(0)
    v_cmp_ne_u32 s[92:93], s66, v224
    s_cmp_lg_u64 s[92:93], 0
    s_cbranch_scc1 L_x2c_spin_20
L_x2c_ok_21:
    s_cmp_lt_u32 s90, 14
    s_cselect_b32 s72, 1.0, 0
    s_nop 6
    v_cvt_pk_bf16_f32 v48, v112, v113
    v_cvt_pk_bf16_f32 v49, v114, v115
    v_cvt_pk_bf16_f32 v50, v116, v117
    v_cvt_pk_bf16_f32 v51, v118, v119
    s_cbranch_vccnz L_far_22
    buffer_store_dwordx4 v[48:51], v1, s[32:35], s14 offen offset:0
L_back_23:
    v_cvt_pk_bf16_f32 v52, v120, v121
    v_cvt_pk_bf16_f32 v53, v122, v123
    v_cvt_pk_bf16_f32 v54, v124, v125
    v_cvt_pk_bf16_f32 v55, v126, v127
    s_cbranch_vccnz L_far_24
    buffer_store_dwordx4 v[52:55], v1, s[32:35], s14 offen offset:1024
L_back_25:
    v_pk_add_f32 v[56:57], v[112:113], v[114:115]
    v_pk_mul_f32 v[58:59], v[112:113], v[112:113]
    v_pk_fma_f32 v[58:59], v[114:115], v[114:115], v[58:59]
    v_pk_add_f32 v[56:57], v[56:57], v[116:117]
    v_pk_fma_f32 v[58:59], v[116:117], v[116:117], v[58:59]
    v_pk_add_f32 v[56:57], v[56:57], v[118:119]
    v_pk_fma_f32 v[58:59], v[118:119], v[118:119], v[58:59]
    v_pk_add_f32 v[56:57], v[56:57], v[120:121]
    v_pk_fma_f32 v[58:59], v[120:121], v[120:121], v[58:59]
    v_pk_add_f32 v[56:57], v[56:57], v[122:123]
    v_pk_fma_f32 v[58:59], v[122:123], v[122:123], v[58:59]
    v_pk_add_f32 v[56:57], v[56:57], v[124:125]
    v_pk_fma_f32 v[58:59], v[124:125], v[124:125], v[58:59]
    v_pk_add_f32 v[56:57], v[56:57], v[126:127]
    v_pk_fma_f32 v[58:59], v[126:127], v[126:127], v[58:59]
    v_add_f32 v56, v56, v57
    v_add_f32 v58, v58, v59
    s_nop 1
    v_permlane32_swap_b32 v56, v58
    v_add_f32 v56, v56, v58
    v_mul_legacy_f32 v56, s72, v56
    ds_write_b32 v250, v56
    s_waitcnt lgkmcnt(0)
    s_barrier
    ds_read_b128 v[56:59], v251
    s_waitcnt vmcnt(0)
    s_cbranch_vccnz L_far_26
    buffer_store_dword v4, v2, s[24:27], s16 offen
L_back_27:
    s_waitcnt lgkmcnt(0)
    v_pk_add_f32 v[56:57], v[56:57], v[58:59]
    v_add_f32 v56, v56, v57
    s_cbranch_vccnz L_far_28
    buffer_store_dword v56, v1, s[52:55], s15 offen
L_back_29:
    s_cmp_ge_u32 s65, 28
    s_cbranch_scc1 L_help
    v_mfma_f32_32x32x16_bf16 v[192:207], v[220:223], v[88:91], v[192:207]
    ds_read_b64_tr_b16 v[88:89], v249 offset:36864
    ds_read_b64_tr_b16 v[90:91], v249 offset:37376
    v_mfma_f32_32x32x16_bf16 v[192:207], v[220:223], v[92:95], v[192:207]
    ds_read_b64_tr_b16 v[92:93], v249 offset:38912
    ds_read_b64_tr_b16 v[94:95], v249 offset:39424
    v_mfma_f32_32x32x16_bf16 v[192:207], v[220:223], v[80:83], v[192:207]
    ds_read_b64_tr_b16 v[80:81], v249 offset:40960
    ds_read_b64_tr_b16 v[82:83], v249 offset:41472
    v_mfma_f32_32x32x16_bf16 v[192:207], v[220:223], v[84:87], v[192:207]
    ds_read_b64_tr_b16 v[84:85], v249 offset:43008
    ds_read_b64_tr_b16 v[86:87], v249 offset:43520
    s_waitcnt vmcnt(0)
    s_cbranch_vccnz L_far_30
    buffer_store_dword v4, v2, s[52:55], s16 offen offset:64
L_back_31:
    buffer_load_dword v14, v13, s[24:27], 0 offen sc1
    s_add_u32 s75, s19, 458752
    s_add_u32 s85, s17, 114688
    s_mov_b32 s77, 0xffff0000
    s_lshl_b32 s72, s65, 10
    s_add_u32 s94, s17, s72
    s_add_u32 s95, s94, 114688
    s_mul_i32 s72, s61, 7168
    s_add_u32 s96, s23, s72
    s_add_u32 s96, s96, 2097152
    s_add_u32 s97, s96, 114688
    s_mul_i32 s73, s61, 5
    s_and_b32 s73, s73, 6
    s_lshl_b32 s74, s70, 3
    s_add_u32 s73, s73, s74
    s_lshl_b32 s74, s73, 9
    s_add_u32 s76, s23, s74
    s_add_u32 s76, s76, 2097152
    s_lshl_b32 s74, s73, 4
    s_add_u32 s23, s23, s74
    s_lshl_b32 s72, s65, 2
    s_sub_u32 s72, s20, s72
    v_min_u32 v247, 27, v0
    v_lshl_add_u32 v247, v247, 2, s72
    s_and_b32 s73, s65, 3
    s_mul_i32 s73, s73, 5
    s_bfe_u32 s73, s73, 131073
    s_sub_u32 s73, s73, s61
    s_lshl_b32 s73, s73, 7
    s_add_u32 s72, s72, s73
    s_mul_i32 s73, s61, 28
    s_add_u32 s72, s72, s73
    s_and_b32 s73, s65, 28
    s_add_u32 s72, s72, s73
    v_writelane_b32 v247, s72, 63
    v_add_u32 v246, 458752, v1
    s_add_u32 s78, s22, 0
    s_add_u32 s79, s22, 4096
    s_add_u32 s80, s22, 8192
    s_add_u32 s81, s22, 12288
    s_add_u32 s82, s22, 16384
    s_add_u32 s83, s22, 20480
    s_add_u32 s84, s22, 24576
    s_waitcnt vmcnt(0)
    v_cmp_ne_u32 s[92:93], s66, v14
    s_cmp_lg_u64 s[92:93], 0
    s_cbranch_scc1 L_x2b_spin_32
L_x2b_ok_33:
    buffer_load_dwordx4 v[16:19], v1, s[24:27], s17 offen offset:0 sc1
    buffer_load_dwordx4 a[0:3], v1, s[24:27], s85 offen offset:0 sc1
    s_waitcnt lgkmcnt(6)
    v_mfma_f32_32x32x16_bf16 v[192:207], v[220:223], v[88:91], v[192:207]
    ds_read_b64_tr_b16 v[88:89], v249 offset:45056
    ds_read_b64_tr_b16 v[90:91], v249 offset:45568
    buffer_load_dwordx4 v[20:23], v1, s[24:27], s17 offen offset:1024 sc1
    s_waitcnt lgkmcnt(6)
    v_mfma_f32_32x32x16_bf16 v[192:207], v[220:223], v[92:95], v[192:207]
    ds_read_b64_tr_b16 v[92:93], v249 offset:47104
    ds_read_b64_tr_b16 v[94:95], v249 offset:47616
    buffer_load_dwordx4 a[4:7], v1, s[24:27], s85 offen offset:1024 sc1
    s_waitcnt lgkmcnt(6)
    v_mfma_f32_32x32x16_bf16 v[192:207], v[220:223], v[80:83], v[192:207]
    ds_read_b64_tr_b16 v[80:81], v249 offset:49152
    ds_read_b64_tr_b16 v[82:83], v249 offset:49664
    buffer_load_dwordx4 v[24:27], v1, s[24:27], s17 offen offset:2048 sc1
    s_waitcnt lgkmcnt(6)
    v_mfma_f32_32x32x16_bf16 v[192:207], v[220:223], v[84:87], v[192:207]
    ds_read_b64_tr_b16 v[84:85], v249 offset:51200
    ds_read_b64_tr_b16 v[86:87], v249 offset:51712
    buffer_load_dwordx4 a[8:11], v1, s[24:27], s85 offen offset:2048 sc1
    s_waitcnt lgkmcnt(6)
    v_mfma_f32_32x32x16_bf16 v[192:207], v[220:223], v[88:91], v[192:207]
    ds_read_b64_tr_b16 v[88:89], v249 offset:53248
    ds_read_b64_tr_b16 v[90:91], v249 offset:53760
    buffer_load_dwordx4 v[28:31], v1, s[24:27], s17 offen offset:3072 sc1
    s_waitcnt lgkmcnt(6)
    v_mfma_f32_32x32x16_bf16 v[192:207], v[220:223], v[92:95], v[192:207]
    ds_read_b64_tr_b16 v[92:93], v249 offset:55296
    ds_read_b64_tr_b16 v[94:95], v249 offset:55808
    buffer_load_dwordx4 a[12:15], v1, s[24:27], s85 offen offset:3072 sc1
    s_waitcnt lgkmcnt(6)
    v_mfma_f32_32x32x16_bf16 v[192:207], v[220:223], v[80:83], v[192:207]
    s_waitcnt lgkmcnt(4)
    v_mfma_f32_32x32x16_bf16 v[192:207], v[220:223], v[84:87], v[192:207]
    s_waitcnt lgkmcnt(2)
    v_mfma_f32_32x32x16_bf16 v[192:207], v[220:223], v[88:91], v[192:207]
    s_waitcnt lgkmcnt(0)
    v_mfma_f32_32x32x16_bf16 v[192:207], v[220:223], v[92:95], v[192:207]
    v_add_u32 v15, 122880, v1
    v_and_b32 v13, 4294967283, v13
    ds_read_b64_tr_b16 v[224:225], v8 offset:0
    ds_read_b64_tr_b16 v[226:227], v8 offset:512
    ds_read_b64_tr_b16 v[228:229], v9 offset:0
    ds_read_b64_tr_b16 v[230:231], v9 offset:512
    s_waitcnt vmcnt(7) lgkmcnt(2)
    v_mfma_f32_32x32x16_bf16 v[128:143], v[224:227], v[16:19], 0
    s_waitcnt vmcnt(6)
    ds_read_b64_tr_b16 v[232:233], v8 offset:2048
    buffer_load_dwordx4 v[32:35], v3, s[24:27], s17 offen offset:0 sc1
    v_mfma_f32_32x32x16_bf16 v[160:175], v[224:227], a[0:3], 0
    s_waitcnt lgkmcnt(1)
    ds_read_b64_tr_b16 v[234:235], v8 offset:2560
    buffer_load_dwordx4 a[16:19], v3, s[24:27], s85 offen offset:0 sc1
    v_mfma_f32_32x32x16_bf16 v[144:159], v[228:231], v[16:19], 0
    ds_read_b64_tr_b16 v[224:225], v9 offset:2048
    buffer_load_dwordx4 v[36:39], v3, s[24:27], s17 offen offset:1024 sc1
    v_mfma_f32_32x32x16_bf16 v[176:191], v[228:231], a[0:3], 0
    s_waitcnt vmcnt(8) lgkmcnt(1)
    ds_read_b64_tr_b16 v[226:227], v9 offset:2560
    buffer_load_dwordx4 a[20:23], v3, s[24:27], s85 offen offset:1024 sc1
    v_mfma_f32_32x32x16_bf16 v[128:143], v[232:235], v[20:23], v[128:143]
    s_waitcnt vmcnt(8)
    ds_read_b64_tr_b16 v[228:229], v8 offset:4096
    buffer_load_dwordx4 v[40:43], v3, s[24:27], s17 offen offset:2048 sc1
    v_and_b32 v193, 0xffff0000, v192
    v_sub_f32 v192, v192, v193
    v_lshrrev_b32 v193, 16, v193
    v_and_b32 v192, 0xffff0000, v192
    v_mfma_f32_32x32x16_bf16 v[160:175], v[232:235], a[4:7], v[160:175]
    s_waitcnt lgkmcnt(1)
    ds_read_b64_tr_b16 v[230:231], v8 offset:4608
    buffer_load_dwordx4 a[24:27], v3, s[24:27], s85 offen offset:2048 sc1
    v_or_b32 v192, v192, v193
    v_mov_b32 v194, 0
    v_mov_b32 v195, 0
    v_mfma_f32_32x32x16_bf16 v[144:159], v[224:227], v[20:23], v[144:159]
    ds_read_b64_tr_b16 v[232:233], v9 offset:4096
    s_mov_b32 exec_lo, 0
    v_mov_b64 v[192:193], 0
    s_mov_b32 exec_lo, -1
    ds_write_b128 v243, v[192:195] offset:8192
    v_mfma_f32_32x32x16_bf16 v[176:191], v[224:227], a[4:7], v[176:191]
    s_waitcnt vmcnt(9) lgkmcnt(2)
    ds_read_b64_tr_b16 v[234:235], v9 offset:4608
    buffer_load_dwordx4 v[44:47], v3, s[24:27], s17 offen offset:3072 sc1
    v_mfma_f32_32x32x16_bf16 v[128:143], v[228:231], v[24:27], v[128:143]
    s_waitcnt vmcnt(9)
    ds_read_b64_tr_b16 v[224:225], v8 offset:6144
    v_mfma_f32_32x32x16_bf16 v[160:175], v[228:231], a[8:11], v[160:175]
    s_waitcnt lgkmcnt(1)
    ds_read_b64_tr_b16 v[226:227], v8 offset:6656
    buffer_load_dwordx4 a[28:31], v3, s[24:27], s85 offen offset:3072 sc1
    v_mfma_f32_32x32x16_bf16 v[144:159], v[232:235], v[24:27], v[144:159]
    ds_read_b64_tr_b16 v[228:229], v9 offset:6144
    v_mfma_f32_32x32x16_bf16 v[176:191], v[232:235], a[8:11], v[176:191]
    s_waitcnt vmcnt(9) lgkmcnt(1)
    ds_read_b64_tr_b16 v[230:231], v9 offset:6656
    s_add_u32 s17, s17, 8192
    buffer_load_dwordx4 v[48:51], v1, s[24:27], s17 offen offset:0 sc1
    v_mfma_f32_32x32x16_bf16 v[128:143], v[224:227], v[28:31], v[128:143]
    s_waitcnt vmcnt(9)
    ds_read_b64_tr_b16 v[232:233], v8 offset:8192
    s_barrier
    v_mfma_f32_32x32x16_bf16 v[160:175], v[224:227], a[12:15], v[160:175]
    s_waitcnt lgkmcnt(1)
    ds_read_b64_tr_b16 v[234:235], v8 offset:8704
    s_add_u32 s85, s85, 8192
    buffer_load_dwordx4 a[32:35], v1, s[24:27], s85 offen offset:0 sc1
    v_mfma_f32_32x32x16_bf16 v[144:159], v[228:231], v[28:31], v[144:159]
    ds_read_b64_tr_b16 v[224:225], v9 offset:8192
    v_mfma_f32_32x32x16_bf16 v[176:191], v[228:231], a[12:15], v[176:191]
    s_waitcnt vmcnt(9) lgkmcnt(1)
    ds_read_b64_tr_b16 v[226:227], v9 offset:8704
    buffer_load_dwordx4 v[52:55], v1, s[24:27], s17 offen offset:1024 sc1
    v_mfma_f32_32x32x16_bf16 v[128:143], v[232:235], v[32:35], v[128:143]
    s_waitcnt vmcnt(9)
    ds_read_b64_tr_b16 v[228:229], v8 offset:10240
    v_mfma_f32_32x32x16_bf16 v[160:175], v[232:235], a[16:19], v[160:175]
    s_waitcnt lgkmcnt(1)
    ds_read_b64_tr_b16 v[230:231], v8 offset:10752
    buffer_load_dwordx4 a[36:39], v1, s[24:27], s85 offen offset:1024 sc1
    v_mfma_f32_32x32x16_bf16 v[144:159], v[224:227], v[32:35], v[144:159]
    ds_read_b64_tr_b16 v[232:233], v9 offset:10240
    v_mfma_f32_32x32x16_bf16 v[176:191], v[224:227], a[16:19], v[176:191]
    s_waitcnt vmcnt(9) lgkmcnt(1)
    ds_read_b64_tr_b16 v[234:235], v9 offset:10752
    buffer_load_dwordx4 v[56:59], v1, s[24:27], s17 offen offset:2048 sc1
    v_mfma_f32_32x32x16_bf16 v[128:143], v[228:231], v[36:39], v[128:143]
    s_waitcnt vmcnt(9)
    ds_read_b64_tr_b16 v[224:225], v8 offset:12288
    buffer_load_dword v14, v13, s[24:27], 0 offen offset:64 sc1
    v_mfma_f32_32x32x16_bf16 v[160:175], v[228:231], a[20:23], v[160:175]
    s_waitcnt lgkmcnt(1)
    ds_read_b64_tr_b16 v[226:227], v8 offset:12800
    buffer_load_dwordx4 a[40:43], v1, s[24:27], s85 offen offset:2048 sc1
    v_mfma_f32_32x32x16_bf16 v[144:159], v[232:235], v[36:39], v[144:159]
    ds_read_b64_tr_b16 v[228:229], v9 offset:12288
    v_mfma_f32_32x32x16_bf16 v[176:191], v[232:235], a[20:23], v[176:191]
    s_waitcnt vmcnt(10) lgkmcnt(1)
    ds_read_b64_tr_b16 v[230:231], v9 offset:12800
    buffer_load_dwordx4 v[60:63], v1, s[24:27], s17 offen offset:3072 sc1
    v_mfma_f32_32x32x16_bf16 v[128:143], v[224:227], v[40:43], v[128:143]
    s_waitcnt vmcnt(10)
    ds_read_b64_tr_b16 v[232:233], v8 offset:14336
    v_mfma_f32_32x32x16_bf16 v[160:175], v[224:227], a[24:27], v[160:175]
    s_waitcnt lgkmcnt(1)
    ds_read_b64_tr_b16 v[234:235], v8 offset:14848
    buffer_load_dwordx4 a[44:47], v1, s[24:27], s85 offen offset:3072 sc1
    v_mfma_f32_32x32x16_bf16 v[144:159], v[228:231], v[40:43], v[144:159]
    ds_read_b64_tr_b16 v[224:225], v9 offset:14336
    v_mfma_f32_32x32x16_bf16 v[176:191], v[228:231], a[24:27], v[176:191]
    s_waitcnt vmcnt(10) lgkmcnt(1)
    ds_read_b64_tr_b16 v[226:227], v9 offset:14848
    buffer_load_dwordx4 v[64:67], v3, s[24:27], s17 offen offset:0 sc1
    v_mfma_f32_32x32x16_bf16 v[128:143], v[232:235], v[44:47], v[128:143]
    s_waitcnt vmcnt(10)
    ds_read_b64_tr_b16 v[228:229], v8 offset:16384
    v_mfma_f32_32x32x16_bf16 v[160:175], v[232:235], a[28:31], v[160:175]
    s_waitcnt lgkmcnt(1)
    ds_read_b64_tr_b16 v[230:231], v8 offset:16896
    buffer_load_dwordx4 a[48:51], v3, s[24:27], s85 offen offset:0 sc1
    v_mfma_f32_32x32x16_bf16 v[144:159], v[224:227], v[44:47], v[144:159]
    ds_read_b64_tr_b16 v[232:233], v9 offset:16384
    v_mfma_f32_32x32x16_bf16 v[176:191], v[224:227], a[28:31], v[176:191]
    s_waitcnt vmcnt(10) lgkmcnt(1)
    ds_read_b64_tr_b16 v[234:235], v9 offset:16896
    buffer_load_dwordx4 v[68:71], v3, s[24:27], s17 offen offset:1024 sc1
    v_mfma_f32_32x32x16_bf16 v[128:143], v[228:231], v[48:51], v[128:143]
    s_waitcnt vmcnt(10)
    ds_read_b64_tr_b16 v[224:225], v8 offset:18432
    v_mfma_f32_32x32x16_bf16 v[160:175], v[228:231], a[32:35], v[160:175]
    s_waitcnt lgkmcnt(1)
    ds_read_b64_tr_b16 v[226:227], v8 offset:18944
    buffer_load_dwordx4 a[52:55], v3, s[24:27], s85 offen offset:1024 sc1
    v_mfma_f32_32x32x16_bf16 v[144:159], v[232:235], v[48:51], v[144:159]
    ds_read_b64_tr_b16 v[228:229], v9 offset:18432
    v_mfma_f32_32x32x16_bf16 v[176:191], v[232:235], a[32:35], v[176:191]
    s_waitcnt vmcnt(10) lgkmcnt(1)
    ds_read_b64_tr_b16 v[230:231], v9 offset:18944
    buffer_load_dwordx4 v[72:75], v3, s[24:27], s17 offen offset:2048 sc1
    v_mfma_f32_32x32x16_bf16 v[128:143], v[224:227], v[52:55], v[128:143]
    s_waitcnt vmcnt(10)
    ds_read_b64_tr_b16 v[232:233], v8 offset:20480
    v_mfma_f32_32x32x16_bf16 v[160:175], v[224:227], a[36:39], v[160:175]
    s_waitcnt lgkmcnt(1)
    ds_read_b64_tr_b16 v[234:235], v8 offset:20992
    buffer_load_dwordx4 a[56:59], v3, s[24:27], s85 offen offset:2048 sc1
    v_mfma_f32_32x32x16_bf16 v[144:159], v[228:231], v[52:55], v[144:159]
    ds_read_b64_tr_b16 v[224:225], v9 offset:20480
    v_mfma_f32_32x32x16_bf16 v[176:191], v[228:231], a[36:39], v[176:191]
    s_waitcnt vmcnt(10) lgkmcnt(1)
    ds_read_b64_tr_b16 v[226:227], v9 offset:20992
    buffer_load_dwordx4 v[76:79], v3, s[24:27], s17 offen offset:3072 sc1
    v_mfma_f32_32x32x16_bf16 v[128:143], v[232:235], v[56:59], v[128:143]
    s_waitcnt vmcnt(9)
    ds_read_b64_tr_b16 v[228:229], v8 offset:22528
    v_mfma_f32_32x32x16_bf16 v[160:175], v[232:235], a[40:43], v[160:175]
    s_waitcnt lgkmcnt(1)
    ds_read_b64_tr_b16 v[230:231], v8 offset:23040
    buffer_load_dwordx4 a[60:63], v3, s[24:27], s85 offen offset:3072 sc1
    v_mfma_f32_32x32x16_bf16 v[144:159], v[224:227], v[56:59], v[144:159]
    ds_read_b64_tr_b16 v[232:233], v9 offset:22528
    v_mfma_f32_32x32x16_bf16 v[176:191], v[224:227], a[40:43], v[176:191]
    s_waitcnt vmcnt(9) lgkmcnt(1)
    ds_read_b64_tr_b16 v[234:235], v9 offset:23040
    s_add_u32 s17, s17, 8192
    buffer_load_dwordx4 v[80:83], v1, s[24:27], s17 offen offset:0 sc1
    v_mfma_f32_32x32x16_bf16 v[128:143], v[228:231], v[60:63], v[128:143]
    s_waitcnt vmcnt(9)
    ds_read_b64_tr_b16 v[224:225], v8 offset:24576
    v_cmp_ne_u32 s[92:93], s66, v14
    s_cmp_lg_u64 s[92:93], 0
    s_cbranch_scc1 L_x2d_spin_34
L_x2d_ok_35:
    buffer_load_dwordx4 v[208:211], v1, s[24:27], s18 offen sc1
    buffer_load_dwordx4 v[212:215], v3, s[24:27], s18 offen sc1
    v_mfma_f32_32x32x16_bf16 v[160:175], v[228:231], a[44:47], v[160:175]
    s_waitcnt lgkmcnt(1)
    ds_read_b64_tr_b16 v[226:227], v8 offset:25088
    v_mfma_f32_32x32x16_bf16 v[144:159], v[232:235], v[60:63], v[144:159]
    ds_read_b64_tr_b16 v[228:229], v9 offset:24576
    v_mfma_f32_32x32x16_bf16 v[176:191], v[232:235], a[44:47], v[176:191]
    s_waitcnt vmcnt(10) lgkmcnt(1)
    ds_read_b64_tr_b16 v[230:231], v9 offset:25088
    v_mfma_f32_32x32x16_bf16 v[128:143], v[224:227], v[64:67], v[128:143]
    s_waitcnt vmcnt(9)
    ds_read_b64_tr_b16 v[232:233], v8 offset:26624
    v_mfma_f32_32x32x16_bf16 v[160:175], v[224:227], a[48:51], v[160:175]
    s_waitcnt lgkmcnt(1)
    ds_read_b64_tr_b16 v[234:235], v8 offset:27136
    s_add_u32 s85, s85, 8192
    buffer_load_dwordx4 a[64:67], v1, s[24:27], s85 offen offset:0 sc1
    v_mfma_f32_32x32x16_bf16 v[144:159], v[228:231], v[64:67], v[144:159]
L_hop_in2:
L_hop_3:
    s_cbranch_execz L_hop_4
    ds_read_b64_tr_b16 v[224:225], v9 offset:26624
    v_mfma_f32_32x32x16_bf16 v[176:191], v[228:231], a[48:51], v[176:191]
    s_waitcnt vmcnt(9) lgkmcnt(1)
    ds_read_b64_tr_b16 v[226:227], v9 offset:27136
    buffer_load_dwordx4 v[84:87], v1, s[24:27], s17 offen offset:1024 sc1
    v_mfma_f32_32x32x16_bf16 v[128:143], v[232:235], v[68:71], v[128:143]
    s_waitcnt vmcnt(9)
    ds_read_b64_tr_b16 v[228:229], v8 offset:28672
    v_mfma_f32_32x32x16_bf16 v[160:175], v[232:235], a[52:55], v[160:175]
    s_waitcnt lgkmcnt(1)
    ds_read_b64_tr_b16 v[230:231], v8 offset:29184
    buffer_load_dwordx4 a[68:71], v1, s[24:27], s85 offen offset:1024 sc1
    v_mfma_f32_32x32x16_bf16 v[144:159], v[224:227], v[68:71], v[144:159]
    ds_read_b64_tr_b16 v[232:233], v9 offset:28672
    v_mfma_f32_32x32x16_bf16 v[176:191], v[224:227], a[52:55], v[176:191]
    s_waitcnt vmcnt(9) lgkmcnt(1)
    ds_read_b64_tr_b16 v[234:235], v9 offset:29184
    buffer_load_dwordx4 v[88:91], v1, s[24:27], s17 offen offset:2048 sc1
    v_mfma_f32_32x32x16_bf16 v[128:143], v[228:231], v[72:75], v[128:143]
    s_waitcnt vmcnt(9)
    ds_read_b64_tr_b16 v[224:225], v8 offset:30720
    v_mfma_f32_32x32x16_bf16 v[160:175], v[228:231], a[56:59], v[160:175]
    s_waitcnt lgkmcnt(1)
    ds_read_b64_tr_b16 v[226:227], v8 offset:31232
    buffer_load_dwordx4 a[72:75], v1, s[24:27], s85 offen offset:2048 sc1
    v_mfma_f32_32x32x16_bf16 v[144:159], v[232:235], v[72:75], v[144:159]
    ds_read_b64_tr_b16 v[228:229], v9 offset:30720
    v_mfma_f32_32x32x16_bf16 v[176:191], v[232:235], a[56:59], v[176:191]
    s_waitcnt vmcnt(9) lgkmcnt(1)
    ds_read_b64_tr_b16 v[230:231], v9 offset:31232
    buffer_load_dwordx4 v[92:95], v1, s[24:27], s17 offen offset:3072 sc1
    v_mfma_f32_32x32x16_bf16 v[128:143], v[224:227], v[76:79], v[128:143]
    s_waitcnt vmcnt(9)
    ds_read_b64_tr_b16 v[232:233], v8 offset:32768
    v_mfma_f32_32x32x16_bf16 v[160:175], v[224:227], a[60:63], v[160:175]
    s_waitcnt lgkmcnt(1)
    ds_read_b64_tr_b16 v[234:235], v8 offset:33280
    buffer_load_dwordx4 a[76:79], v1, s[24:27], s85 offen offset:3072 sc1
    v_mfma_f32_32x32x16_bf16 v[144:159], v[228:231], v[76:79], v[144:159]
    ds_read_b64_tr_b16 v[224:225], v9 offset:32768
    v_mfma_f32_32x32x16_bf16 v[176:191], v[228:231], a[60:63], v[176:191]
    s_waitcnt vmcnt(9) lgkmcnt(1)
    ds_read_b64_tr_b16 v[226:227], v9 offset:33280
    buffer_load_dwordx4 v[96:99], v3, s[24:27], s17 offen offset:0 sc1
    v_mfma_f32_32x32x16_bf16 v[128:143], v[232:235], v[80:83], v[128:143]
    s_waitcnt vmcnt(7)
    ds_read_b64_tr_b16 v[228:229], v8 offset:34816
    buffer_load_dwordx4 a[80:83], v3, s[24:27], s85 offen offset:0 sc1
    v_mfma_f32_32x32x16_bf16 v[160:175], v[232:235], a[64:67], v[160:175]
    s_waitcnt lgkmcnt(1)
    ds_read_b64_tr_b16 v[230:231], v8 offset:35328
    buffer_load_dwordx4 v[100:103], v3, s[24:27], s17 offen offset:1024 sc1
    v_mfma_f32_32x32x16_bf16 v[144:159], v[224:227], v[80:83], v[144:159]
    ds_read_b64_tr_b16 v[232:233], v9 offset:34816
    buffer_load_dwordx4 a[84:87], v3, s[24:27], s85 offen offset:1024 sc1
    v_mfma_f32_32x32x16_bf16 v[176:191], v[224:227], a[64:67], v[176:191]
    s_waitcnt vmcnt(9) lgkmcnt(1)
    ds_read_b64_tr_b16 v[234:235], v9 offset:35328
    buffer_load_dwordx4 v[104:107], v3, s[24:27], s17 offen offset:2048 sc1
    v_mfma_f32_32x32x16_bf16 v[128:143], v[228:231], v[84:87], v[128:143]
    s_waitcnt vmcnt(9)
    ds_read_b64_tr_b16 v[224:225], v8 offset:36864
    v_mfma_f32_32x32x16_bf16 v[160:175], v[228:231], a[68:71], v[160:175]
    s_waitcnt lgkmcnt(1)
    ds_read_b64_tr_b16 v[226:227], v8 offset:37376
    buffer_load_dwordx4 a[88:91], v3, s[24:27], s85 offen offset:2048 sc1
    v_mfma_f32_32x32x16_bf16 v[144:159], v[232:235], v[84:87], v[144:159]
    ds_read_b64_tr_b16 v[228:229], v9 offset:36864
    v_mfma_f32_32x32x16_bf16 v[176:191], v[232:235], a[68:71], v[176:191]
    s_waitcnt vmcnt(9) lgkmcnt(1)
    ds_read_b64_tr_b16 v[230:231], v9 offset:37376
    buffer_load_dwordx4 v[108:111], v3, s[24:27], s17 offen offset:3072 sc1
    v_mfma_f32_32x32x16_bf16 v[128:143], v[224:227], v[88:91], v[128:143]
    s_waitcnt vmcnt(9)
    ds_read_b64_tr_b16 v[232:233], v8 offset:38912
    v_add_f32 v208, v208, v209
    v_add_f32 v212, v212, v213
    v_add_f32 v210, v210, v211
    v_mfma_f32_32x32x16_bf16 v[160:175], v[224:227], a[72:75], v[160:175]
    s_waitcnt lgkmcnt(1)
    ds_read_b64_tr_b16 v[234:235], v8 offset:39424
    buffer_load_dwordx4 a[92:95], v3, s[24:27], s85 offen offset:3072 sc1
    v_add_f32 v214, v214, v215
    v_add_f32 v208, v208, v210
    v_add_f32 v212, v212, v214
    v_mul_f32 v208, 0x3b124925, v208
    v_mfma_f32_32x32x16_bf16 v[144:159], v[228:231], v[88:91], v[144:159]
    ds_read_b64_tr_b16 v[224:225], v9 offset:38912
    v_mul_f32 v212, 0x3b124925, v212
    v_mov_b32 v209, v208
    v_mov_b32 v213, v212
    v_mov_b32 v252, 0
    v_mov_b32 v253, 0
    v_permlane32_swap_b32 v208, v209
    v_mfma_f32_32x32x16_bf16 v[176:191], v[228:231], a[72:75], v[176:191]
    s_waitcnt vmcnt(9) lgkmcnt(1)
    ds_read_b64_tr_b16 v[226:227], v9 offset:39424
    s_add_u32 s17, s17, 8192
    buffer_load_dwordx4 v[112:115], v1, s[24:27], s17 offen offset:0 sc1
    v_permlane32_swap_b32 v212, v213
    v_fma_f32 v209, -v208, v208, v209
    v_fma_f32 v213, -v212, v212, v213
    v_max_f32 v209, 0, v209
    v_mfma_f32_32x32x16_bf16 v[128:143], v[232:235], v[92:95], v[128:143]
    s_waitcnt vmcnt(9)
    ds_read_b64_tr_b16 v[228:229], v8 offset:40960
    v_max_f32 v213, 0, v213
    v_add_f32 v5, 0x3727c5ac, v209
    v_add_f32 v13, 0x3727c5ac, v213
    v_rsq_f32 v209, v5
    v_mfma_f32_32x32x16_bf16 v[160:175], v[232:235], a[76:79], v[160:175]
    s_waitcnt lgkmcnt(1)
    ds_read_b64_tr_b16 v[230:231], v8 offset:41472
    s_add_u32 s85, s85, 8192
    buffer_load_dwordx4 a[96:99], v1, s[24:27], s85 offen offset:0 sc1
    v_rsq_f32 v213, v13
    v_sub_f32 v208, 0, v208
    v_sub_f32 v212, 0, v212
    v_mfma_f32_32x32x16_bf16 v[144:159], v[224:227], v[92:95], v[144:159]
    ds_read_b64_tr_b16 v[232:233], v9 offset:40960
    v_mul_f32 v238, 0xc0135761, v209
    v_mul_f32 v244, 0xc0135761, v213
    v_mul_f32 v209, v209, v209
    v_mul_f32 v213, v213, v213
    v_mul_f32 v239, 0x3d372713, v209
    v_mul_f32 v245, 0x3d372713, v213
    v_mfma_f32_32x32x16_bf16 v[176:191], v[224:227], a[76:79], v[176:191]
    s_waitcnt vmcnt(9) lgkmcnt(1)
    ds_read_b64_tr_b16 v[234:235], v9 offset:41472
    buffer_load_dwordx4 v[116:119], v1, s[24:27], s17 offen offset:1024 sc1
    v_mul_f32 v239, v239, v238
    v_mul_f32 v245, v245, v244
    v_and_b32 v210, s77, v208
    v_and_b32 v214, s77, v212
    v_mfma_f32_32x32x16_bf16 v[128:143], v[228:231], v[96:99], v[128:143]
    s_waitcnt vmcnt(9)
    ds_read_b64_tr_b16 v[224:225], v8 offset:43008
    v_sub_f32 v209, v208, v210
    v_sub_f32 v213, v212, v214
    v_lshrrev_b32 v249, 16, v209
    v_lshrrev_b32 v251, 16, v213
    v_lshrrev_b32 v208, 16, v210
    v_lshrrev_b32 v212, 16, v214
    v_mfma_f32_32x32x16_bf16 v[160:175], v[228:231], a[80:83], v[160:175]
    s_waitcnt lgkmcnt(1)
    ds_read_b64_tr_b16 v[226:227], v8 offset:43520
    buffer_load_dwordx4 a[100:103], v1, s[24:27], s85 offen offset:1024 sc1
    v_or_b32 v248, v208, v210
    v_or_b32 v250, v212, v214
    v_mfma_f32_32x32x16_bf16 v[144:159], v[232:235], v[96:99], v[144:159]
    ds_read_b64_tr_b16 v[228:229], v9 offset:43008
    v_mfma_f32_32x32x16_bf16 v[176:191], v[232:235], a[80:83], v[176:191]
    s_waitcnt vmcnt(9) lgkmcnt(1)
    ds_read_b64_tr_b16 v[230:231], v9 offset:43520
    buffer_load_dwordx4 v[120:123], v1, s[24:27], s17 offen offset:2048 sc1
    v_mfma_f32_32x32x16_bf16 v[128:143], v[224:227], v[100:103], v[128:143]
    s_waitcnt vmcnt(9)
    ds_read_b64_tr_b16 v[232:233], v8 offset:45056
    v_mfma_f32_32x32x16_bf16 v[160:175], v[224:227], a[84:87], v[160:175]
    s_waitcnt lgkmcnt(1)
    ds_read_b64_tr_b16 v[234:235], v8 offset:45568
    buffer_load_dwordx4 a[104:107], v1, s[24:27], s85 offen offset:2048 sc1
    v_mfma_f32_32x32x16_bf16 v[144:159], v[228:231], v[100:103], v[144:159]
    ds_read_b64_tr_b16 v[224:225], v9 offset:45056
    v_mfma_f32_32x32x16_bf16 v[176:191], v[228:231], a[84:87], v[176:191]
    s_waitcnt vmcnt(9) lgkmcnt(1)
    ds_read_b64_tr_b16 v[226:227], v9 offset:45568
    buffer_load_dwordx4 v[124:127], v1, s[24:27], s17 offen offset:3072 sc1
    v_mfma_f32_32x32x16_bf16 v[128:143], v[232:235], v[104:107], v[128:143]
    s_waitcnt vmcnt(9)
    ds_read_b64_tr_b16 v[228:229], v8 offset:47104
    v_mfma_f32_32x32x16_bf16 v[160:175], v[232:235], a[88:91], v[160:175]
    s_waitcnt lgkmcnt(1)
    ds_read_b64_tr_b16 v[230:231], v8 offset:47616
    buffer_load_dwordx4 a[108:111], v1, s[24:27], s85 offen offset:3072 sc1
    v_mfma_f32_32x32x16_bf16 v[144:159], v[224:227], v[104:107], v[144:159]
    ds_read_b64_tr_b16 v[232:233], v9 offset:47104
    v_mfma_f32_32x32x16_bf16 v[176:191], v[224:227], a[88:91], v[176:191]
    s_waitcnt vmcnt(9) lgkmcnt(1)
    ds_read_b64_tr_b16 v[234:235], v9 offset:47616
    buffer_load_dwordx4 a[172:175], v7, s[44:47], s21 offen offset:2048 sc1
    v_mfma_f32_32x32x16_bf16 v[128:143], v[228:231], v[108:111], v[128:143]
    s_waitcnt vmcnt(9)
    ds_read_b64_tr_b16 v[224:225], v8 offset:49152
    v_mfma_f32_32x32x16_bf16 v[160:175], v[228:231], a[92:95], v[160:175]
    s_waitcnt lgkmcnt(1)
    ds_read_b64_tr_b16 v[226:227], v8 offset:49664
    s_add_u32 s21, s21, 8192
    buffer_load_dwordx4 a[176:179], v6, s[44:47], s21 offen offset:2048 sc1
    v_mfma_f32_32x32x16_bf16 v[144:159], v[232:235], v[108:111], v[144:159]
    ds_read_b64_tr_b16 v[228:229], v9 offset:49152
    v_mfma_f32_32x32x16_bf16 v[176:191], v[232:235], a[92:95], v[176:191]
    s_waitcnt vmcnt(9) lgkmcnt(1)
    ds_read_b64_tr_b16 v[230:231], v9 offset:49664
    buffer_load_dwordx4 a[180:183], v7, s[44:47], s21 offen offset:2048 sc1
    v_mfma_f32_32x32x16_bf16 v[128:143], v[224:227], v[112:115], v[128:143]
    s_waitcnt vmcnt(9)
    ds_read_b64_tr_b16 v[232:233], v8 offset:51200
    v_mfma_f32_32x32x16_bf16 v[160:175], v[224:227], a[96:99], v[160:175]
    s_waitcnt lgkmcnt(1)
    ds_read_b64_tr_b16 v[234:235], v8 offset:51712
    s_add_u32 s21, s21, 8192
    buffer_load_dwordx4 a[184:187], v6, s[44:47], s21 offen offset:2048 sc1
    v_mfma_f32_32x32x16_bf16 v[144:159], v[228:231], v[112:115], v[144:159]
    ds_read_b64_tr_b16 v[224:225], v9 offset:51200
    v_mfma_f32_32x32x16_bf16 v[176:191], v[228:231], a[96:99], v[176:191]
    s_waitcnt vmcnt(9) lgkmcnt(1)
    ds_read_b64_tr_b16 v[226:227], v9 offset:51712
    buffer_load_dwordx4 a[188:191], v7, s[44:47], s21 offen offset:2048 sc1
    v_mfma_f32_32x32x16_bf16 v[128:143], v[232:235], v[116:119], v[128:143]
    s_waitcnt vmcnt(9)
    ds_read_b64_tr_b16 v[228:229], v8 offset:53248
    buffer_load_dwordx4 a[248:251], v1, s[24:27], s76 offen sc1
    s_add_u32 s76, s76, 114688
    buffer_load_dwordx4 a[252:255], v1, s[24:27], s76 offen sc1
    v_mfma_f32_32x32x16_bf16 v[160:175], v[232:235], a[100:103], v[160:175]
    s_waitcnt lgkmcnt(1)
    ds_read_b64_tr_b16 v[230:231], v8 offset:53760
    v_mfma_f32_32x32x16_bf16 v[144:159], v[224:227], v[116:119], v[144:159]
    ds_read_b64_tr_b16 v[232:233], v9 offset:53248
    v_mfma_f32_32x32x16_bf16 v[176:191], v[224:227], a[100:103], v[176:191]
    s_waitcnt vmcnt(10) lgkmcnt(1)
    ds_read_b64_tr_b16 v[234:235], v9 offset:53760
    v_mfma_f32_32x32x16_bf16 v[128:143], v[228:231], v[120:123], v[128:143]
    s_waitcnt vmcnt(9)
    ds_read_b64_tr_b16 v[224:225], v8 offset:55296
    v_mfma_f32_32x32x16_bf16 v[160:175], v[228:231], a[104:107], v[160:175]
    s_waitcnt lgkmcnt(1)
    ds_read_b64_tr_b16 v[226:227], v8 offset:55808
    s_add_u32 s21, s21, 8192
    buffer_load_dwordx4 a[192:195], v6, s[44:47], s21 offen offset:2048 sc1
    v_mfma_f32_32x32x16_bf16 v[144:159], v[232:235], v[120:123], v[144:159]
    ds_read_b64_tr_b16 v[228:229], v9 offset:55296
    v_mfma_f32_32x32x16_bf16 v[176:191], v[232:235], a[104:107], v[176:191]
    s_waitcnt vmcnt(9) lgkmcnt(1)
    ds_read_b64_tr_b16 v[230:231], v9 offset:55808
    buffer_load_dwordx4 a[196:199], v7, s[44:47], s21 offen offset:2048 sc1
    v_mfma_f32_32x32x16_bf16 v[128:143], v[224:227], v[124:127], v[128:143]
    s_waitcnt vmcnt(9)
    v_mfma_f32_32x32x16_bf16 v[160:175], v[224:227], a[108:111], v[160:175]
    s_waitcnt lgkmcnt(0)
    ds_read_b128 v[232:235], v15 offset:0
    s_add_u32 s21, s21, 8192
    buffer_load_dwordx4 a[200:203], v6, s[44:47], s21 offen offset:2048 sc1
    v_mfma_f32_32x32x16_bf16 v[144:159], v[228:231], v[124:127], v[144:159]
    v_mfma_f32_32x32x16_bf16 v[176:191], v[228:231], a[108:111], v[176:191]
    s_waitcnt lgkmcnt(0)
    ds_read_b128 v[224:227], v15 offset:12288
    buffer_load_dwordx4 a[204:207], v7, s[44:47], s21 offen offset:2048 sc1
    v_mfma_f32_32x32x16_bf16 v[128:143], v[232:235], v[248:251], v[128:143]
    ds_read_b64_tr_b16 v[228:229], v10 offset:0
    v_mfma_f32_32x32x16_bf16 v[160:175], v[232:235], v[250:253], v[160:175]
    s_waitcnt lgkmcnt(1)
    ds_read_b64_tr_b16 v[230:231], v10 offset:512
    s_add_u32 s21, s21, 8192
    buffer_load_dwordx4 a[208:211], v6, s[44:47], s21 offen offset:2048 sc1
    v_mfma_f32_32x32x16_bf16 v[144:159], v[224:227], v[248:251], v[144:159]
    ds_read_b64_tr_b16 v[232:233], v10 offset:2048
    v_mfma_f32_32x32x16_bf16 v[176:191], v[224:227], v[250:253], v[176:191]
    s_waitcnt lgkmcnt(1)
    ds_read_b64_tr_b16 v[234:235], v10 offset:2560
    buffer_load_dwordx4 a[212:215], v7, s[44:47], s21 offen offset:2048 sc1
    v_mfma_f32_32x32x16_bf16 v[192:207], v[228:231], v[16:19], 0
    ds_read_b64_tr_b16 v[224:225], v10 offset:4096
    v_mfma_f32_32x32x16_bf16 v[208:223], v[228:231], a[0:3], 0
    s_waitcnt lgkmcnt(1)
    ds_read_b64_tr_b16 v[226:227], v10 offset:4608
    s_add_u32 s21, s21, 8192
    buffer_load_dwordx4 a[216:219], v6, s[44:47], s21 offen offset:2048 sc1
    v_mfma_f32_32x32x16_bf16 v[192:207], v[232:235], v[20:23], v[192:207]
    ds_read_b64_tr_b16 v[228:229], v10 offset:6144
    v_mul_f32 v236, v128, v128
    v_mul_f32 v237, v129, v129
    v_fma_f32 v236, v236, v239, v238
    v_fma_f32 v237, v237, v239, v238
    v_mul_f32 v236, v236, v128
    v_mfma_f32_32x32x16_bf16 v[208:223], v[232:235], a[4:7], v[208:223]
    s_waitcnt lgkmcnt(1)
    ds_read_b64_tr_b16 v[230:231], v10 offset:6656
    buffer_load_dwordx4 a[220:223], v7, s[44:47], s21 offen offset:2048 sc1
    v_mul_f32 v237, v237, v129
    v_exp_f32 v236, v236
    v_mfma_f32_32x32x16_bf16 v[192:207], v[224:227], v[24:27], v[192:207]
    ds_read_b64_tr_b16 v[232:233], v10 offset:8192
    v_exp_f32 v237, v237
    v_mul_f32 v136, v128, v136
    v_fma_f32 v236, v236, v5, v5
    v_fma_f32 v237, v237, v5, v5
    v_mfma_f32_32x32x16_bf16 v[208:223], v[224:227], a[8:11], v[208:223]
    s_waitcnt lgkmcnt(1)
    ds_read_b64_tr_b16 v[234:235], v10 offset:8704
    s_add_u32 s21, s21, 4294922240
    buffer_load_dwordx4 a[224:227], v6, s[44:47], s21 offen offset:0 sc1
    v_rcp_f32 v236, v236
    v_rcp_f32 v237, v237
    v_mfma_f32_32x32x16_bf16 v[192:207], v[228:231], v[28:31], v[192:207]
    ds_read_b64_tr_b16 v[224:225], v10 offset:10240
    v_mul_f32 v137, v129, v137
    v_mul_f32 v236, v236, v136
    v_mul_f32 v237, v237, v137
    v_cvt_pk_bf16_f32 v240, v236, v237
    v_mul_f32 v236, v130, v130
    v_mul_f32 v237, v131, v131
    v_mfma_f32_32x32x16_bf16 v[208:223], v[228:231], a[12:15], v[208:223]
    s_waitcnt lgkmcnt(1)
    ds_read_b64_tr_b16 v[226:227], v10 offset:10752
    buffer_load_dwordx4 a[228:231], v7, s[44:47], s21 offen offset:0 sc1
    v_fma_f32 v236, v236, v239, v238
    v_fma_f32 v237, v237, v239, v238
    v_mul_f32 v236, v236, v130
    v_mul_f32 v237, v237, v131
    v_mfma_f32_32x32x16_bf16 v[192:207], v[232:235], v[32:35], v[192:207]
    ds_read_b64_tr_b16 v[228:229], v10 offset:12288
    v_exp_f32 v236, v236
    v_exp_f32 v237, v237
    v_mul_f32 v138, v130, v138
    v_fma_f32 v236, v236, v5, v5
    v_mfma_f32_32x32x16_bf16 v[208:223], v[232:235], a[16:19], v[208:223]
    s_waitcnt lgkmcnt(1)
    ds_read_b64_tr_b16 v[230:231], v10 offset:12800
    s_add_u32 s21, s21, 8192
    buffer_load_dwordx4 a[232:235], v6, s[44:47], s21 offen offset:0 sc1
    v_fma_f32 v237, v237, v5, v5
    v_rcp_f32 v236, v236
    v_mfma_f32_32x32x16_bf16 v[192:207], v[224:227], v[36:39], v[192:207]
    ds_read_b64_tr_b16 v[232:233], v10 offset:14336
    v_rcp_f32 v237, v237
    v_mul_f32 v139, v131, v139
    v_mul_f32 v236, v236, v138
    v_mul_f32 v237, v237, v139
    v_cvt_pk_bf16_f32 v241, v236, v237
    v_mfma_f32_32x32x16_bf16 v[208:223], v[224:227], a[20:23], v[208:223]
    s_waitcnt lgkmcnt(1)
    ds_read_b64_tr_b16 v[234:235], v10 offset:14848
    buffer_load_dwordx4 a[236:239], v7, s[44:47], s21 offen offset:0 sc1
    v_mul_f32 v236, v132, v132
    v_mul_f32 v237, v133, v133
    v_fma_f32 v236, v236, v239, v238
    v_fma_f32 v237, v237, v239, v238
    v_mfma_f32_32x32x16_bf16 v[192:207], v[228:231], v[40:43], v[192:207]
    ds_read_b64_tr_b16 v[224:225], v10 offset:16384
    v_mul_f32 v236, v236, v132
    v_mul_f32 v237, v237, v133
    v_exp_f32 v236, v236
    v_exp_f32 v237, v237
    v_mfma_f32_32x32x16_bf16 v[208:223], v[228:231], a[24:27], v[208:223]
    s_waitcnt lgkmcnt(1)
    ds_read_b64_tr_b16 v[226:227], v10 offset:16896
    s_add_u32 s21, s21, 8192
    buffer_load_dwordx4 a[240:243], v6, s[44:47], s21 offen offset:0 sc1
    v_mul_f32 v140, v132, v140
    v_fma_f32 v236, v236, v5, v5
    v_fma_f32 v237, v237, v5, v5
    v_mfma_f32_32x32x16_bf16 v[192:207], v[232:235], v[44:47], v[192:207]
    ds_read_b64_tr_b16 v[228:229], v10 offset:18432
    v_rcp_f32 v236, v236
    v_rcp_f32 v237, v237
    v_mul_f32 v141, v133, v141
    v_mul_f32 v236, v236, v140
    v_mfma_f32_32x32x16_bf16 v[208:223], v[232:235], a[28:31], v[208:223]
    s_waitcnt lgkmcnt(1)
    ds_read_b64_tr_b16 v[230:231], v10 offset:18944
    buffer_load_dwordx4 a[244:247], v7, s[44:47], s21 offen offset:0 sc1
    v_mul_f32 v237, v237, v141
    v_cvt_pk_bf16_f32 v242, v236, v237
    v_mul_f32 v236, v134, v134
    v_mul_f32 v237, v135, v135
    v_mfma_f32_32x32x16_bf16 v[192:207], v[224:227], v[48:51], v[192:207]
    ds_read_b64_tr_b16 v[232:233], v10 offset:20480
    v_fma_f32 v236, v236, v239, v238
    v_fma_f32 v237, v237, v239, v238
    v_mul_f32 v236, v236, v134
    v_mul_f32 v237, v237, v135
    v_exp_f32 v236, v236
    v_mfma_f32_32x32x16_bf16 v[208:223], v[224:227], a[32:35], v[208:223]
    s_waitcnt lgkmcnt(1)
    ds_read_b64_tr_b16 v[234:235], v10 offset:20992
    v_exp_f32 v237, v237
    v_mul_f32 v142, v134, v142
    v_fma_f32 v236, v236, v5, v5
    v_fma_f32 v237, v237, v5, v5
    v_mfma_f32_32x32x16_bf16 v[192:207], v[228:231], v[52:55], v[192:207]
    ds_read_b64_tr_b16 v[224:225], v10 offset:22528
    v_rcp_f32 v236, v236
    v_rcp_f32 v237, v237
    v_mul_f32 v143, v135, v143
    v_mul_f32 v236, v236, v142
    v_mfma_f32_32x32x16_bf16 v[208:223], v[228:231], a[36:39], v[208:223]
    s_waitcnt lgkmcnt(1)
    ds_read_b64_tr_b16 v[226:227], v10 offset:23040
    v_mul_f32 v237, v237, v143
    v_cvt_pk_bf16_f32 v243, v236, v237
    buffer_store_dwordx4 v[240:243], v1, s[24:27], s19 offen offset:0 sc1
    v_mul_f32 v236, v144, v144
    v_mfma_f32_32x32x16_bf16 v[192:207], v[232:235], v[56:59], v[192:207]
    ds_read_b64_tr_b16 v[228:229], v10 offset:24576
    v_mul_f32 v237, v145, v145
    v_fma_f32 v236, v236, v239, v238
    v_fma_f32 v237, v237, v239, v238
    v_mul_f32 v236, v236, v144
    v_mul_f32 v237, v237, v145
    v_mfma_f32_32x32x16_bf16 v[208:223], v[232:235], a[40:43], v[208:223]
    s_waitcnt lgkmcnt(1)
    ds_read_b64_tr_b16 v[230:231], v10 offset:25088
    v_exp_f32 v236, v236
    v_exp_f32 v237, v237
    v_mul_f32 v152, v144, v152
    v_fma_f32 v236, v236, v5, v5
    v_mfma_f32_32x32x16_bf16 v[192:207], v[224:227], v[60:63], v[192:207]
    ds_read_b64_tr_b16 v[232:233], v10 offset:26624
    v_fma_f32 v237, v237, v5, v5
    v_rcp_f32 v236, v236
    v_rcp_f32 v237, v237
    v_mul_f32 v153, v145, v153
    v_mfma_f32_32x32x16_bf16 v[208:223], v[224:227], a[44:47], v[208:223]
    s_waitcnt lgkmcnt(1)
    ds_read_b64_tr_b16 v[234:235], v10 offset:27136
    v_mul_f32 v236, v236, v152
    v_mul_f32 v237, v237, v153
    v_cvt_pk_bf16_f32 v240, v236, v237
    v_mul_f32 v236, v146, v146
    v_mul_f32 v237, v147, v147
    v_mfma_f32_32x32x16_bf16 v[192:207], v[228:231], v[64:67], v[192:207]
    ds_read_b64_tr_b16 v[224:225], v10 offset:28672
    v_fma_f32 v236, v236, v239, v238
    v_fma_f32 v237, v237, v239, v238
    v_mul_f32 v236, v236, v146
    v_mul_f32 v237, v237, v147
    v_mfma_f32_32x32x16_bf16 v[208:223], v[228:231], a[48:51], v[208:223]
    s_waitcnt lgkmcnt(1)
    ds_read_b64_tr_b16 v[226:227], v10 offset:29184
    v_exp_f32 v236, v236
    v_exp_f32 v237, v237
    v_mul_f32 v154, v146, v154
    v_fma_f32 v236, v236, v5, v5
    v_mfma_f32_32x32x16_bf16 v[192:207], v[232:235], v[68:71], v[192:207]
    ds_read_b64_tr_b16 v[228:229], v10 offset:30720
    v_fma_f32 v237, v237, v5, v5
    v_rcp_f32 v236, v236
    v_rcp_f32 v237, v237
    v_mfma_f32_32x32x16_bf16 v[208:223], v[232:235], a[52:55], v[208:223]
    s_waitcnt lgkmcnt(1)
    ds_read_b64_tr_b16 v[230:231], v10 offset:31232
    v_mul_f32 v155, v147, v155
    v_mul_f32 v236, v236, v154
    v_mul_f32 v237, v237, v155
    v_cvt_pk_bf16_f32 v241, v236, v237
    v_mul_f32 v236, v148, v148
    v_mfma_f32_32x32x16_bf16 v[192:207], v[224:227], v[72:75], v[192:207]
    ds_read_b64_tr_b16 v[232:233], v10 offset:32768
    v_mul_f32 v237, v149, v149
    v_fma_f32 v236, v236, v239, v238
    v_fma_f32 v237, v237, v239, v238
    v_mul_f32 v236, v236, v148
    v_mul_f32 v237, v237, v149
    v_mfma_f32_32x32x16_bf16 v[208:223], v[224:227], a[56:59], v[208:223]
    s_waitcnt lgkmcnt(1)
    ds_read_b64_tr_b16 v[234:235], v10 offset:33280
    v_exp_f32 v236, v236
    v_exp_f32 v237, v237
    v_mul_f32 v156, v148, v156
    v_mfma_f32_32x32x16_bf16 v[192:207], v[228:231], v[76:79], v[192:207]
    ds_read_b64_tr_b16 v[224:225], v10 offset:34816
    v_fma_f32 v236, v236, v5, v5
    v_fma_f32 v237, v237, v5, v5
    v_rcp_f32 v236, v236
    v_mfma_f32_32x32x16_bf16 v[208:223], v[228:231], a[60:63], v[208:223]
    s_waitcnt lgkmcnt(1)
    ds_read_b64_tr_b16 v[226:227], v10 offset:35328
    v_rcp_f32 v237, v237
    v_mul_f32 v157, v149, v157
    v_mul_f32 v236, v236, v156
    v_mul_f32 v237, v237, v157
    v_cvt_pk_bf16_f32 v242, v236, v237
    v_mfma_f32_32x32x16_bf16 v[192:207], v[232:235], v[80:83], v[192:207]
    ds_read_b64_tr_b16 v[228:229], v10 offset:36864
    v_mul_f32 v236, v150, v150
    v_mul_f32 v237, v151, v151
    v_fma_f32 v236, v236, v239, v238
    v_fma_f32 v237, v237, v239, v238
    v_mul_f32 v236, v236, v150
    v_mfma_f32_32x32x16_bf16 v[208:223], v[232:235], a[64:67], v[208:223]
    s_waitcnt lgkmcnt(1)
    ds_read_b64_tr_b16 v[230:231], v10 offset:37376
    v_mul_f32 v237, v237, v151
    v_exp_f32 v236, v236
    v_exp_f32 v237, v237
    v_mfma_f32_32x32x16_bf16 v[192:207], v[224:227], v[84:87], v[192:207]
    ds_read_b64_tr_b16 v[232:233], v11 offset:0
    v_mul_f32 v158, v150, v158
    v_fma_f32 v236, v236, v5, v5
    v_fma_f32 v237, v237, v5, v5
    v_rcp_f32 v236, v236
    v_mfma_f32_32x32x16_bf16 v[208:223], v[224:227], a[68:71], v[208:223]
    s_waitcnt lgkmcnt(1)
    ds_read_b64_tr_b16 v[234:235], v11 offset:512
    v_rcp_f32 v237, v237
    v_mul_f32 v159, v151, v159
    v_mul_f32 v236, v236, v158
    v_mul_f32 v237, v237, v159
    v_mfma_f32_32x32x16_bf16 v[192:207], v[228:231], v[88:91], v[192:207]
    ds_read_b64_tr_b16 v[224:225], v11 offset:2048
    v_cvt_pk_bf16_f32 v243, v236, v237
    buffer_store_dwordx4 v[240:243], v1, s[24:27], s19 offen offset:1024 sc1
    v_mul_f32 v236, v160, v160
    v_mfma_f32_32x32x16_bf16 v[208:223], v[228:231], a[72:75], v[208:223]
    s_waitcnt lgkmcnt(1)
    ds_read_b64_tr_b16 v[226:227], v11 offset:2560
    v_mul_f32 v237, v161, v161
    v_fma_f32 v236, v236, v245, v244
    v_fma_f32 v237, v237, v245, v244
    v_mul_f32 v236, v236, v160
    v_mul_f32 v237, v237, v161
    v_mfma_f32_32x32x16_bf16 v[128:143], v[232:235], v[16:19], 0
    ds_read_b64_tr_b16 v[228:229], v11 offset:4096
    v_exp_f32 v236, v236
    v_exp_f32 v237, v237
    v_mul_f32 v168, v160, v168
    v_mfma_f32_32x32x16_bf16 v[144:159], v[232:235], a[0:3], 0
    s_waitcnt lgkmcnt(1)
    ds_read_b64_tr_b16 v[230:231], v11 offset:4608
    s_add_u32 s21, s21, 8192
    buffer_load_dwordx4 a[0:3], v6, s[44:47], s21 offen offset:0 sc1
    v_fma_f32 v236, v236, v13, v13
    v_fma_f32 v237, v237, v13, v13
    v_rcp_f32 v236, v236
    v_mfma_f32_32x32x16_bf16 v[128:143], v[224:227], v[20:23], v[128:143]
    ds_read_b64_tr_b16 v[232:233], v11 offset:6144
    v_rcp_f32 v237, v237
    v_mul_f32 v169, v161, v169
    v_mul_f32 v236, v236, v168
    v_mul_f32 v237, v237, v169
    v_cvt_pk_bf16_f32 v240, v236, v237
    v_mfma_f32_32x32x16_bf16 v[144:159], v[224:227], a[4:7], v[144:159]
    s_waitcnt lgkmcnt(1)
    ds_read_b64_tr_b16 v[234:235], v11 offset:6656
    buffer_load_dwordx4 a[4:7], v7, s[44:47], s21 offen offset:0 sc1
    v_mul_f32 v236, v162, v162
    v_mul_f32 v237, v163, v163
    v_fma_f32 v236, v236, v245, v244
    v_fma_f32 v237, v237, v245, v244
    v_mfma_f32_32x32x16_bf16 v[128:143], v[228:231], v[24:27], v[128:143]
    ds_read_b64_tr_b16 v[224:225], v11 offset:8192
    v_mul_f32 v236, v236, v162
    v_mul_f32 v237, v237, v163
    v_exp_f32 v236, v236
    v_exp_f32 v237, v237
    v_mfma_f32_32x32x16_bf16 v[144:159], v[228:231], a[8:11], v[144:159]
    s_waitcnt lgkmcnt(1)
    ds_read_b64_tr_b16 v[226:227], v11 offset:8704
    s_add_u32 s21, s21, 8192
    buffer_load_dwordx4 a[8:11], v6, s[44:47], s21 offen offset:0 sc1
    v_mul_f32 v170, v162, v170
    v_fma_f32 v236, v236, v13, v13
    v_fma_f32 v237, v237, v13, v13
    v_mfma_f32_32x32x16_bf16 v[128:143], v[232:235], v[28:31], v[128:143]
    ds_read_b64_tr_b16 v[228:229], v11 offset:10240
    v_rcp_f32 v236, v236
    v_rcp_f32 v237, v237
    v_mul_f32 v171, v163, v171
    v_mul_f32 v236, v236, v170
    v_mfma_f32_32x32x16_bf16 v[144:159], v[232:235], a[12:15], v[144:159]
    s_waitcnt lgkmcnt(1)
    ds_read_b64_tr_b16 v[230:231], v11 offset:10752
    buffer_load_dwordx4 a[12:15], v7, s[44:47], s21 offen offset:0 sc1
    v_mul_f32 v237, v237, v171
    v_cvt_pk_bf16_f32 v241, v236, v237
    v_mul_f32 v236, v164, v164
    v_mul_f32 v237, v165, v165
    v_mfma_f32_32x32x16_bf16 v[128:143], v[224:227], v[32:35], v[128:143]
    ds_read_b64_tr_b16 v[232:233], v11 offset:12288
    v_fma_f32 v236, v236, v245, v244
    v_fma_f32 v237, v237, v245, v244
    v_mul_f32 v236, v236, v164
    v_mul_f32 v237, v237, v165
    v_exp_f32 v236, v236
    v_mfma_f32_32x32x16_bf16 v[144:159], v[224:227], a[16:19], v[144:159]
    s_waitcnt lgkmcnt(1)
    ds_read_b64_tr_b16 v[234:235], v11 offset:12800
    s_add_u32 s21, s21, 8192
    buffer_load_dwordx4 a[16:19], v6, s[44:47], s21 offen offset:0 sc1
    v_exp_f32 v237, v237
    v_mul_f32 v172, v164, v172
    v_fma_f32 v236, v236, v13, v13
    v_mfma_f32_32x32x16_bf16 v[128:143], v[228:231], v[36:39], v[128:143]
    ds_read_b64_tr_b16 v[224:225], v11 offset:14336
    v_fma_f32 v237, v237, v13, v13
    v_rcp_f32 v236, v236
    v_rcp_f32 v237, v237
    v_mul_f32 v173, v165, v173
    v_mfma_f32_32x32x16_bf16 v[144:159], v[228:231], a[20:23], v[144:159]
    s_waitcnt lgkmcnt(1)
    ds_read_b64_tr_b16 v[226:227], v11 offset:14848
    buffer_load_dwordx4 a[20:23], v7, s[44:47], s21 offen offset:0 sc1
    v_mul_f32 v236, v236, v172
    v_mul_f32 v237, v237, v173
    v_cvt_pk_bf16_f32 v242, v236, v237
    v_mul_f32 v236, v166, v166
    v_mfma_f32_32x32x16_bf16 v[128:143], v[232:235], v[40:43], v[128:143]
    ds_read_b64_tr_b16 v[228:229], v11 offset:16384
    v_mul_f32 v237, v167, v167
    v_fma_f32 v236, v236, v245, v244
    v_fma_f32 v237, v237, v245, v244
    v_mul_f32 v236, v236, v166
    v_mul_f32 v237, v237, v167
    v_mfma_f32_32x32x16_bf16 v[144:159], v[232:235], a[24:27], v[144:159]
    s_waitcnt lgkmcnt(1)
    ds_read_b64_tr_b16 v[230:231], v11 offset:16896
    s_add_u32 s21, s21, 8192
    buffer_load_dwordx4 a[24:27], v6, s[44:47], s21 offen offset:0 sc1
    v_exp_f32 v236, v236
    v_exp_f32 v237, v237
    v_mfma_f32_32x32x16_bf16 v[128:143], v[224:227], v[44:47], v[128:143]
    ds_read_b64_tr_b16 v[232:233], v11 offset:18432
    s_waitcnt vmcnt(7)
    s_cbranch_vccnz L_far_36
    buffer_store_dword v4, v2, s[24:27], s20 offen offset:0
L_back_37:
    v_mul_f32 v174, v166, v174
    v_fma_f32 v236, v236, v13, v13
    v_fma_f32 v237, v237, v13, v13
    v_mfma_f32_32x32x16_bf16 v[144:159], v[224:227], a[28:31], v[144:159]
    s_waitcnt lgkmcnt(1)
    ds_read_b64_tr_b16 v[234:235], v11 offset:18944
    buffer_load_dwordx4 a[28:31], v7, s[44:47], s21 offen offset:0 sc1
    v_rcp_f32 v236, v236
    v_rcp_f32 v237, v237
    v_mfma_f32_32x32x16_bf16 v[128:143], v[228:231], v[48:51], v[128:143]
    ds_read_b64_tr_b16 v[224:225], v10 offset:38912
    v_mul_f32 v175, v167, v175
    v_mul_f32 v236, v236, v174
    v_mul_f32 v237, v237, v175
    v_cvt_pk_bf16_f32 v243, v236, v237
    v_mfma_f32_32x32x16_bf16 v[144:159], v[228:231], a[32:35], v[144:159]
    s_waitcnt lgkmcnt(1)
    ds_read_b64_tr_b16 v[226:227], v10 offset:39424
    s_add_u32 s21, s21, 4294918144
    buffer_load_dwordx4 a[32:35], v6, s[44:47], s21 offen offset:2048 sc1
    buffer_store_dwordx4 v[240:243], v1, s[24:27], s75 offen offset:0 sc1
    v_mul_f32 v236, v176, v176
    v_mfma_f32_32x32x16_bf16 v[128:143], v[232:235], v[52:55], v[128:143]
L_hop_in3:
L_hop_4:
    s_cbranch_execz L_hop_5
    ds_read_b64_tr_b16 v[228:229], v10 offset:40960
    buffer_load_dwordx4 v[160:163], v7, s[44:47], s21 offen offset:2048 sc1
    v_mul_f32 v237, v177, v177
    v_fma_f32 v236, v236, v245, v244
    v_fma_f32 v237, v237, v245, v244
    v_mul_f32 v236, v236, v176
    v_mfma_f32_32x32x16_bf16 v[144:159], v[232:235], a[36:39], v[144:159]
    s_waitcnt lgkmcnt(1)
    ds_read_b64_tr_b16 v[230:231], v10 offset:41472
    s_add_u32 s21, s21, 8192
    buffer_load_dwordx4 a[36:39], v6, s[44:47], s21 offen offset:2048 sc1
    v_mul_f32 v237, v237, v177
    v_exp_f32 v236, v236
    v_mfma_f32_32x32x16_bf16 v[192:207], v[224:227], v[92:95], v[192:207]
    ds_read_b64_tr_b16 v[232:233], v10 offset:43008
    buffer_load_dwordx4 v[164:167], v7, s[44:47], s21 offen offset:2048 sc1
    v_exp_f32 v237, v237
    v_mul_f32 v184, v176, v184
    v_fma_f32 v236, v236, v13, v13
    v_mfma_f32_32x32x16_bf16 v[208:223], v[224:227], a[76:79], v[208:223]
    s_waitcnt lgkmcnt(1)
    ds_read_b64_tr_b16 v[234:235], v10 offset:43520
    s_add_u32 s21, s21, 8192
    buffer_load_dwordx4 v[168:171], v6, s[44:47], s21 offen offset:2048 sc1
    v_fma_f32 v237, v237, v13, v13
    v_rcp_f32 v236, v236
    v_mfma_f32_32x32x16_bf16 v[192:207], v[228:231], v[96:99], v[192:207]
    ds_read_b64_tr_b16 v[224:225], v10 offset:45056
    buffer_load_dwordx4 v[172:175], v7, s[44:47], s21 offen offset:2048 sc1
    v_rcp_f32 v237, v237
    v_mul_f32 v185, v177, v185
    v_mul_f32 v236, v236, v184
    v_mfma_f32_32x32x16_bf16 v[208:223], v[228:231], a[80:83], v[208:223]
    s_waitcnt lgkmcnt(1)
    ds_read_b64_tr_b16 v[226:227], v10 offset:45568
    v_mul_f32 v237, v237, v185
    v_cvt_pk_bf16_f32 v240, v236, v237
    v_mul_f32 v236, v178, v178
    v_mul_f32 v237, v179, v179
    v_fma_f32 v236, v236, v245, v244
    v_fma_f32 v237, v237, v245, v244
    v_mfma_f32_32x32x16_bf16 v[192:207], v[232:235], v[100:103], v[192:207]
    ds_read_b64_tr_b16 v[228:229], v10 offset:47104
    v_mul_f32 v236, v236, v178
    v_mul_f32 v237, v237, v179
    v_exp_f32 v236, v236
    v_exp_f32 v237, v237
    v_mfma_f32_32x32x16_bf16 v[208:223], v[232:235], a[84:87], v[208:223]
    s_waitcnt lgkmcnt(1)
    ds_read_b64_tr_b16 v[230:231], v10 offset:47616
    v_mul_f32 v186, v178, v186
    v_fma_f32 v236, v236, v13, v13
    v_fma_f32 v237, v237, v13, v13
    v_rcp_f32 v236, v236
    v_mfma_f32_32x32x16_bf16 v[192:207], v[224:227], v[104:107], v[192:207]
    ds_read_b64_tr_b16 v[232:233], v10 offset:49152
    v_rcp_f32 v237, v237
    v_mul_f32 v187, v179, v187
    v_mul_f32 v236, v236, v186
    v_mul_f32 v237, v237, v187
    v_cvt_pk_bf16_f32 v241, v236, v237
    v_mfma_f32_32x32x16_bf16 v[208:223], v[224:227], a[88:91], v[208:223]
    s_waitcnt lgkmcnt(1)
    ds_read_b64_tr_b16 v[234:235], v10 offset:49664
    v_mul_f32 v236, v180, v180
    v_mul_f32 v237, v181, v181
    v_fma_f32 v236, v236, v245, v244
    v_fma_f32 v237, v237, v245, v244
    v_mul_f32 v236, v236, v180
    v_mul_f32 v237, v237, v181
    v_mfma_f32_32x32x16_bf16 v[192:207], v[228:231], v[108:111], v[192:207]
    ds_read_b64_tr_b16 v[224:225], v10 offset:51200
    v_exp_f32 v236, v236
    v_exp_f32 v237, v237
    v_mul_f32 v188, v180, v188
    v_fma_f32 v236, v236, v13, v13
    v_mfma_f32_32x32x16_bf16 v[208:223], v[228:231], a[92:95], v[208:223]
    s_waitcnt lgkmcnt(1)
    ds_read_b64_tr_b16 v[226:227], v10 offset:51712
    v_fma_f32 v237, v237, v13, v13
    v_rcp_f32 v236, v236
    v_rcp_f32 v237, v237
    v_mul_f32 v189, v181, v189
    v_mfma_f32_32x32x16_bf16 v[192:207], v[232:235], v[112:115], v[192:207]
    ds_read_b64_tr_b16 v[228:229], v10 offset:53248
    v_mul_f32 v236, v236, v188
    v_mul_f32 v237, v237, v189
    v_cvt_pk_bf16_f32 v242, v236, v237
    v_mul_f32 v236, v182, v182
    v_mul_f32 v237, v183, v183
    v_fma_f32 v236, v236, v245, v244
    v_mfma_f32_32x32x16_bf16 v[208:223], v[232:235], a[96:99], v[208:223]
    s_waitcnt lgkmcnt(1)
    ds_read_b64_tr_b16 v[230:231], v10 offset:53760
    v_fma_f32 v237, v237, v245, v244
    v_mul_f32 v236, v236, v182
    v_mul_f32 v237, v237, v183
    v_exp_f32 v236, v236
    v_mfma_f32_32x32x16_bf16 v[192:207], v[224:227], v[116:119], v[192:207]
    ds_read_b64_tr_b16 v[232:233], v10 offset:55296
    v_exp_f32 v237, v237
    v_mul_f32 v190, v182, v190
    v_fma_f32 v236, v236, v13, v13
    v_fma_f32 v237, v237, v13, v13
    v_mfma_f32_32x32x16_bf16 v[208:223], v[224:227], a[100:103], v[208:223]
    s_waitcnt lgkmcnt(1)
    ds_read_b64_tr_b16 v[234:235], v10 offset:55808
    v_rcp_f32 v236, v236
    v_rcp_f32 v237, v237
    v_mul_f32 v191, v183, v191
    v_mul_f32 v236, v236, v190
    v_mfma_f32_32x32x16_bf16 v[192:207], v[228:231], v[120:123], v[192:207]
    v_mul_f32 v237, v237, v191
    v_cvt_pk_bf16_f32 v243, v236, v237
    buffer_store_dwordx4 v[240:243], v1, s[24:27], s75 offen offset:1024 sc1
    v_mfma_f32_32x32x16_bf16 v[208:223], v[228:231], a[104:107], v[208:223]
    s_waitcnt lgkmcnt(0)
    ds_read_b128 v[224:227], v15 offset:24576
    s_add_u32 s21, s21, 8192
    buffer_load_dwordx4 v[176:179], v6, s[44:47], s21 offen offset:2048 sc1
    v_mfma_f32_32x32x16_bf16 v[192:207], v[232:235], v[124:127], v[192:207]
    ds_read_b64_tr_b16 v[228:229], v11 offset:20480
    buffer_load_dwordx4 v[180:183], v7, s[44:47], s21 offen offset:2048 sc1
    v_mfma_f32_32x32x16_bf16 v[208:223], v[232:235], a[108:111], v[208:223]
    s_waitcnt lgkmcnt(1)
    ds_read_b64_tr_b16 v[230:231], v11 offset:20992
    s_add_u32 s21, s21, 8192
    buffer_load_dwordx4 v[184:187], v6, s[44:47], s21 offen offset:2048 sc1
    v_mfma_f32_32x32x16_bf16 v[192:207], v[224:227], v[248:251], v[192:207]
    ds_read_b64_tr_b16 v[232:233], v11 offset:22528
    buffer_load_dword v14, v12, s[24:27], 0 offen offset:0 sc1
    buffer_load_dwordx4 v[188:191], v7, s[44:47], s21 offen offset:2048 sc1
    v_mfma_f32_32x32x16_bf16 v[208:223], v[224:227], v[250:253], v[208:223]
    s_waitcnt lgkmcnt(1)
    ds_read_b64_tr_b16 v[234:235], v11 offset:23040
    v_mfma_f32_32x32x16_bf16 v[128:143], v[228:231], v[56:59], v[128:143]
    ds_read_b64_tr_b16 v[224:225], v11 offset:24576
    v_mfma_f32_32x32x16_bf16 v[144:159], v[228:231], a[40:43], v[144:159]
    s_waitcnt lgkmcnt(1)
    ds_read_b64_tr_b16 v[226:227], v11 offset:25088
    s_add_u32 s21, s21, 8192
    buffer_load_dwordx4 a[40:43], v6, s[44:47], s21 offen offset:2048 sc1
    v_mfma_f32_32x32x16_bf16 v[128:143], v[232:235], v[60:63], v[128:143]
    ds_read_b64_tr_b16 v[228:229], v11 offset:26624
    v_mfma_f32_32x32x16_bf16 v[144:159], v[232:235], a[44:47], v[144:159]
    s_waitcnt lgkmcnt(1)
    ds_read_b64_tr_b16 v[230:231], v11 offset:27136
    buffer_load_dwordx4 a[44:47], v7, s[44:47], s21 offen offset:2048 sc1
    v_mfma_f32_32x32x16_bf16 v[128:143], v[224:227], v[64:67], v[128:143]
    ds_read_b64_tr_b16 v[232:233], v11 offset:28672
    v_mul_f32 v236, v192, v192
    v_mul_f32 v237, v193, v193
    v_fma_f32 v236, v236, v239, v238
    v_fma_f32 v237, v237, v239, v238
    v_mul_f32 v236, v236, v192
    v_mul_f32 v237, v237, v193
    v_mfma_f32_32x32x16_bf16 v[144:159], v[224:227], a[48:51], v[144:159]
    s_waitcnt lgkmcnt(1)
    ds_read_b64_tr_b16 v[234:235], v11 offset:29184
    s_add_u32 s21, s21, 8192
    buffer_load_dwordx4 a[48:51], v6, s[44:47], s21 offen offset:2048 sc1
    v_exp_f32 v236, v236
    v_exp_f32 v237, v237
    v_mfma_f32_32x32x16_bf16 v[128:143], v[228:231], v[68:71], v[128:143]
    ds_read_b64_tr_b16 v[224:225], v11 offset:30720
    v_mul_f32 v200, v192, v200
    v_fma_f32 v236, v236, v5, v5
    v_fma_f32 v237, v237, v5, v5
    v_rcp_f32 v236, v236
    v_mfma_f32_32x32x16_bf16 v[144:159], v[228:231], a[52:55], v[144:159]
    s_waitcnt lgkmcnt(1)
    ds_read_b64_tr_b16 v[226:227], v11 offset:31232
    buffer_load_dwordx4 a[52:55], v7, s[44:47], s21 offen offset:2048 sc1
    v_rcp_f32 v237, v237
    v_mul_f32 v201, v193, v201
    v_mul_f32 v236, v236, v200
    v_mfma_f32_32x32x16_bf16 v[128:143], v[232:235], v[72:75], v[128:143]
    ds_read_b64_tr_b16 v[228:229], v11 offset:32768
    v_mul_f32 v237, v237, v201
    v_cvt_pk_bf16_f32 v240, v236, v237
    v_mul_f32 v236, v194, v194
    v_mul_f32 v237, v195, v195
    v_fma_f32 v236, v236, v239, v238
    v_fma_f32 v237, v237, v239, v238
    v_mfma_f32_32x32x16_bf16 v[144:159], v[232:235], a[56:59], v[144:159]
    s_waitcnt lgkmcnt(1)
    ds_read_b64_tr_b16 v[230:231], v11 offset:33280
    v_mul_f32 v236, v236, v194
    v_mul_f32 v237, v237, v195
    v_exp_f32 v236, v236
    v_exp_f32 v237, v237
    v_mfma_f32_32x32x16_bf16 v[128:143], v[224:227], v[76:79], v[128:143]
    ds_read_b64_tr_b16 v[232:233], v11 offset:34816
    v_mul_f32 v202, v194, v202
    v_fma_f32 v236, v236, v5, v5
    v_fma_f32 v237, v237, v5, v5
    v_rcp_f32 v236, v236
    v_mfma_f32_32x32x16_bf16 v[144:159], v[224:227], a[60:63], v[144:159]
    s_waitcnt lgkmcnt(1)
    ds_read_b64_tr_b16 v[234:235], v11 offset:35328
    v_rcp_f32 v237, v237
    v_mul_f32 v203, v195, v203
    v_mul_f32 v236, v236, v202
    v_mul_f32 v237, v237, v203
    v_cvt_pk_bf16_f32 v241, v236, v237
    v_mfma_f32_32x32x16_bf16 v[128:143], v[228:231], v[80:83], v[128:143]
    ds_read_b64_tr_b16 v[224:225], v11 offset:36864
    s_waitcnt vmcnt(9)
    s_cbranch_vccnz L_far_38
    buffer_store_dword v4, v2, s[24:27], s20 offen offset:512
L_back_39:
    v_mul_f32 v236, v196, v196
    v_mul_f32 v237, v197, v197
    v_fma_f32 v236, v236, v239, v238
    v_mfma_f32_32x32x16_bf16 v[144:159], v[228:231], a[64:67], v[144:159]
    s_waitcnt lgkmcnt(1)
    ds_read_b64_tr_b16 v[226:227], v11 offset:37376
    v_fma_f32 v237, v237, v239, v238
    v_mul_f32 v236, v236, v196
    v_mul_f32 v237, v237, v197
    v_exp_f32 v236, v236
    v_mfma_f32_32x32x16_bf16 v[128:143], v[232:235], v[84:87], v[128:143]
    ds_read_b64_tr_b16 v[228:229], v11 offset:38912
    v_exp_f32 v237, v237
    v_mul_f32 v204, v196, v204
    v_fma_f32 v236, v236, v5, v5
    v_fma_f32 v237, v237, v5, v5
    v_mfma_f32_32x32x16_bf16 v[144:159], v[232:235], a[68:71], v[144:159]
    s_waitcnt lgkmcnt(1)
    ds_read_b64_tr_b16 v[230:231], v11 offset:39424
    v_rcp_f32 v236, v236
    v_rcp_f32 v237, v237
    v_mul_f32 v205, v197, v205
    v_mul_f32 v236, v236, v204
    v_mfma_f32_32x32x16_bf16 v[128:143], v[224:227], v[88:91], v[128:143]
    ds_read_b64_tr_b16 v[232:233], v11 offset:40960
    v_mul_f32 v237, v237, v205
    v_cvt_pk_bf16_f32 v242, v236, v237
    v_mul_f32 v236, v198, v198
    v_mul_f32 v237, v199, v199
    v_fma_f32 v236, v236, v239, v238
    v_fma_f32 v237, v237, v239, v238
    v_mfma_f32_32x32x16_bf16 v[144:159], v[224:227], a[72:75], v[144:159]
    s_waitcnt lgkmcnt(1)
    ds_read_b64_tr_b16 v[234:235], v11 offset:41472
    v_mul_f32 v236, v236, v198
    v_mul_f32 v237, v237, v199
    v_exp_f32 v236, v236
    v_exp_f32 v237, v237
    v_mfma_f32_32x32x16_bf16 v[128:143], v[228:231], v[92:95], v[128:143]
    ds_read_b64_tr_b16 v[224:225], v11 offset:43008
    v_mul_f32 v206, v198, v206
    v_fma_f32 v236, v236, v5, v5
    v_fma_f32 v237, v237, v5, v5
    v_rcp_f32 v236, v236
    v_mfma_f32_32x32x16_bf16 v[144:159], v[228:231], a[76:79], v[144:159]
    s_waitcnt lgkmcnt(1)
    ds_read_b64_tr_b16 v[226:227], v11 offset:43520
    s_waitcnt vmcnt(6)
    v_xor_b32 v14, s66, v14
    v_lshlrev_b32 v14, 1, v14
    v_cmp_ne_u32 s[92:93], 0, v14
    s_cmp_lg_u64 s[92:93], 0
    s_cbranch_scc1 L_x3_0_spin_40
L_x3_0_ok_41:
    buffer_load_dwordx4 a[56:59], v1, s[24:27], s78 offen offset:0 sc1
    v_rcp_f32 v237, v237
    v_mfma_f32_32x32x16_bf16 v[128:143], v[232:235], v[96:99], v[128:143]
    ds_read_b64_tr_b16 v[228:229], v11 offset:45056
    buffer_load_dwordx4 a[60:63], v1, s[24:27], s79 offen offset:0 sc1
    v_mul_f32 v207, v199, v207
    v_mul_f32 v236, v236, v206
    v_mul_f32 v237, v237, v207
    v_cvt_pk_bf16_f32 v243, v236, v237
    v_mfma_f32_32x32x16_bf16 v[144:159], v[232:235], a[80:83], v[144:159]
    s_waitcnt lgkmcnt(1)
    ds_read_b64_tr_b16 v[230:231], v11 offset:45568
    buffer_load_dwordx4 a[64:67], v1, s[24:27], s80 offen offset:0 sc1
    buffer_store_dwordx4 v[240:243], v1, s[24:27], s19 offen offset:2048 sc1
    v_mul_f32 v236, v208, v208
    v_mfma_f32_32x32x16_bf16 v[128:143], v[224:227], v[100:103], v[128:143]
    ds_read_b64_tr_b16 v[232:233], v11 offset:47104
    buffer_load_dwordx4 a[68:71], v1, s[24:27], s81 offen offset:0 sc1
    v_mul_f32 v237, v209, v209
    v_fma_f32 v236, v236, v245, v244
    v_fma_f32 v237, v237, v245, v244
    v_mul_f32 v236, v236, v208
    v_mfma_f32_32x32x16_bf16 v[144:159], v[224:227], a[84:87], v[144:159]
    s_waitcnt lgkmcnt(1)
    ds_read_b64_tr_b16 v[234:235], v11 offset:47616
    v_mul_f32 v237, v237, v209
    v_exp_f32 v236, v236
    v_exp_f32 v237, v237
    v_mul_f32 v216, v208, v216
    v_mfma_f32_32x32x16_bf16 v[128:143], v[228:231], v[104:107], v[128:143]
    ds_read_b64_tr_b16 v[224:225], v11 offset:49152
    buffer_load_dwordx4 a[72:75], v1, s[24:27], s82 offen offset:0 sc1
    v_fma_f32 v236, v236, v13, v13
    v_fma_f32 v237, v237, v13, v13
    v_rcp_f32 v236, v236
    v_mfma_f32_32x32x16_bf16 v[144:159], v[228:231], a[88:91], v[144:159]
    s_waitcnt lgkmcnt(1)
    ds_read_b64_tr_b16 v[226:227], v11 offset:49664
    v_rcp_f32 v237, v237
    v_mul_f32 v217, v209, v217
    v_mul_f32 v236, v236, v216
    v_mul_f32 v237, v237, v217
    v_cvt_pk_bf16_f32 v240, v236, v237
    v_mfma_f32_32x32x16_bf16 v[128:143], v[232:235], v[108:111], v[128:143]
    ds_read_b64_tr_b16 v[228:229], v11 offset:51200
    buffer_load_dwordx4 a[76:79], v1, s[24:27], s83 offen offset:0 sc1
    v_mul_f32 v236, v210, v210
    v_mul_f32 v237, v211, v211
    v_fma_f32 v236, v236, v245, v244
    v_fma_f32 v237, v237, v245, v244
    v_mfma_f32_32x32x16_bf16 v[144:159], v[232:235], a[92:95], v[144:159]
    s_waitcnt lgkmcnt(1)
    ds_read_b64_tr_b16 v[230:231], v11 offset:51712
    v_mul_f32 v236, v236, v210
    v_mul_f32 v237, v237, v211
    v_exp_f32 v236, v236
    v_exp_f32 v237, v237
    v_mfma_f32_32x32x16_bf16 v[128:143], v[224:227], v[112:115], v[128:143]
    ds_read_b64_tr_b16 v[232:233], v11 offset:53248
    buffer_load_dwordx4 a[80:83], v1, s[24:27], s84 offen offset:0 sc1
    v_mul_f32 v218, v210, v218
    v_fma_f32 v236, v236, v13, v13
    v_fma_f32 v237, v237, v13, v13
    v_mfma_f32_32x32x16_bf16 v[144:159], v[224:227], a[96:99], v[144:159]
    s_waitcnt lgkmcnt(1)
    ds_read_b64_tr_b16 v[234:235], v11 offset:53760
    v_rcp_f32 v236, v236
    v_rcp_f32 v237, v237
    v_mul_f32 v219, v211, v219
    v_mul_f32 v236, v236, v218
    v_mfma_f32_32x32x16_bf16 v[128:143], v[228:231], v[116:119], v[128:143]
    ds_read_b64_tr_b16 v[224:225], v11 offset:55296
    buffer_load_dword v14, v12, s[24:27], 0 offen offset:512 sc1
    buffer_load_dwordx4 a[84:87], v1, s[24:27], s78 offen offset:1024 sc1
    v_mul_f32 v237, v237, v219
    v_cvt_pk_bf16_f32 v241, v236, v237
    v_mul_f32 v236, v212, v212
    v_mfma_f32_32x32x16_bf16 v[144:159], v[228:231], a[100:103], v[144:159]
    s_waitcnt lgkmcnt(1)
    ds_read_b64_tr_b16 v[226:227], v11 offset:55808
    v_mul_f32 v237, v213, v213
    v_fma_f32 v236, v236, v245, v244
    v_fma_f32 v237, v237, v245, v244
    v_mul_f32 v236, v236, v212
    v_mul_f32 v237, v237, v213
    v_mfma_f32_32x32x16_bf16 v[128:143], v[232:235], v[120:123], v[128:143]
    buffer_load_dwordx4 a[88:91], v1, s[24:27], s79 offen offset:1024 sc1
    v_exp_f32 v236, v236
    v_exp_f32 v237, v237
    v_mfma_f32_32x32x16_bf16 v[144:159], v[232:235], a[104:107], v[144:159]
    s_waitcnt lgkmcnt(0)
    ds_read_b128 v[228:231], v15 offset:36864
    v_mul_f32 v220, v212, v220
    v_fma_f32 v236, v236, v13, v13
    v_fma_f32 v237, v237, v13, v13
    v_rcp_f32 v236, v236
    v_mfma_f32_32x32x16_bf16 v[128:143], v[224:227], v[124:127], v[128:143]
    buffer_load_dwordx4 a[92:95], v1, s[24:27], s80 offen offset:1024 sc1
    v_rcp_f32 v237, v237
    v_mul_f32 v221, v213, v221
    v_mul_f32 v236, v236, v220
    v_mfma_f32_32x32x16_bf16 v[144:159], v[224:227], a[108:111], v[144:159]
    s_waitcnt lgkmcnt(0)
    v_mul_f32 v237, v237, v221
    v_cvt_pk_bf16_f32 v242, v236, v237
    v_mul_f32 v236, v214, v214
    v_mul_f32 v237, v215, v215
    v_fma_f32 v236, v236, v245, v244
    v_fma_f32 v237, v237, v245, v244
    v_mfma_f32_32x32x16_bf16 v[128:143], v[228:231], v[248:251], v[128:143]
    buffer_load_dword v15, v247, s[24:27], 0 offen sc1
    buffer_load_dwordx4 a[96:99], v1, s[24:27], s81 offen offset:1024 sc1
    v_mul_f32 v236, v236, v214
    v_mul_f32 v237, v237, v215
    v_exp_f32 v236, v236
    v_mfma_f32_32x32x16_bf16 v[144:159], v[228:231], v[250:253], v[144:159]
    v_exp_f32 v237, v237
    v_mul_f32 v222, v214, v222
    v_fma_f32 v236, v236, v13, v13
    v_fma_f32 v237, v237, v13, v13
    s_waitcnt vmcnt(13)
    v_mfma_f32_32x32x16_bf16 v[16:31], a[112:115], a[56:59], 0
    buffer_load_dwordx4 a[100:103], v1, s[24:27], s82 offen offset:1024 sc1
    v_rcp_f32 v236, v236
    v_rcp_f32 v237, v237
    v_mul_f32 v223, v215, v223
    v_mul_f32 v236, v236, v222
    v_mul_f32 v237, v237, v223
    v_cvt_pk_bf16_f32 v243, v236, v237
    v_mfma_f32_32x32x16_bf16 v[32:47], a[116:119], a[56:59], 0
    s_waitcnt vmcnt(13)
    buffer_store_dwordx4 v[240:243], v1, s[24:27], s75 offen offset:2048 sc1
    v_mfma_f32_32x32x16_bf16 v[16:31], a[120:123], a[60:63], v[16:31]
    v_mfma_f32_32x32x16_bf16 v[32:47], a[124:127], a[60:63], v[32:47]
    s_waitcnt vmcnt(13)
    v_mfma_f32_32x32x16_bf16 v[16:31], a[128:131], a[64:67], v[16:31]
    v_mfma_f32_32x32x16_bf16 v[32:47], a[132:135], a[64:67], v[32:47]
    s_waitcnt vmcnt(11)
    buffer_load_dwordx4 a[104:107], v1, s[24:27], s83 offen offset:1024 sc1
    v_mfma_f32_32x32x16_bf16 v[16:31], a[136:139], a[68:71], v[16:31]
    v_mfma_f32_32x32x16_bf16 v[32:47], a[140:143], a[68:71], v[32:47]
    s_waitcnt vmcnt(11)
    buffer_load_dwordx4 a[108:111], v1, s[24:27], s84 offen offset:1024 sc1
    v_mul_f32 v236, v128, v128
    v_mul_f32 v237, v129, v129
    v_fma_f32 v236, v236, v239, v238
    v_fma_f32 v237, v237, v239, v238
    v_mul_f32 v236, v236, v128
    v_mul_f32 v237, v237, v129
    v_exp_f32 v236, v236
    v_exp_f32 v237, v237
    v_mfma_f32_32x32x16_bf16 v[16:31], a[144:147], a[72:75], v[16:31]
    s_cbranch_vccnz L_far_42
    buffer_store_dword v4, v2, s[24:27], s20 offen offset:1024
L_back_43:
    v_mul_f32 v136, v128, v136
    v_fma_f32 v236, v236, v5, v5
    v_fma_f32 v237, v237, v5, v5
    v_rcp_f32 v236, v236
    v_rcp_f32 v237, v237
    v_mul_f32 v137, v129, v137
    v_mul_f32 v236, v236, v136
    v_mul_f32 v237, v237, v137
    v_mfma_f32_32x32x16_bf16 v[32:47], a[148:151], a[72:75], v[32:47]
    s_waitcnt vmcnt(12)
    v_cvt_pk_bf16_f32 v240, v236, v237
    v_mul_f32 v236, v130, v130
    v_mul_f32 v237, v131, v131
    v_fma_f32 v236, v236, v239, v238
    v_fma_f32 v237, v237, v239, v238
    v_mul_f32 v236, v236, v130
    v_mul_f32 v237, v237, v131
    v_exp_f32 v236, v236
    v_mfma_f32_32x32x16_bf16 v[16:31], a[152:155], a[76:79], v[16:31]
    v_exp_f32 v237, v237
    v_mul_f32 v138, v130, v138
    v_fma_f32 v236, v236, v5, v5
    v_fma_f32 v237, v237, v5, v5
    v_rcp_f32 v236, v236
    v_rcp_f32 v237, v237
    v_mul_f32 v139, v131, v139
    v_mfma_f32_32x32x16_bf16 v[32:47], a[156:159], a[76:79], v[32:47]
    s_waitcnt vmcnt(11)
    v_mul_f32 v236, v236, v138
    v_mul_f32 v237, v237, v139
    v_cvt_pk_bf16_f32 v241, v236, v237
    v_mul_f32 v236, v132, v132
    v_mul_f32 v237, v133, v133
    v_fma_f32 v236, v236, v239, v238
    v_fma_f32 v237, v237, v239, v238
    v_mul_f32 v236, v236, v132
    v_mul_f32 v237, v237, v133
    v_mfma_f32_32x32x16_bf16 v[16:31], a[160:163], a[80:83], v[16:31]
    v_exp_f32 v236, v236
    v_exp_f32 v237, v237
    v_mul_f32 v140, v132, v140
    v_fma_f32 v236, v236, v5, v5
    v_fma_f32 v237, v237, v5, v5
    v_rcp_f32 v236, v236
    v_mfma_f32_32x32x16_bf16 v[32:47], a[164:167], a[80:83], v[32:47]
    s_waitcnt vmcnt(9)
    v_rcp_f32 v237, v237
    v_mul_f32 v141, v133, v141
    v_mul_f32 v236, v236, v140
    v_mul_f32 v237, v237, v141
    v_cvt_pk_bf16_f32 v242, v236, v237
    v_mul_f32 v236, v134, v134
    v_mul_f32 v237, v135, v135
    v_fma_f32 v236, v236, v239, v238
    v_fma_f32 v237, v237, v239, v238
    v_mfma_f32_32x32x16_bf16 v[16:31], a[168:171], a[84:87], v[16:31]
    v_mul_f32 v236, v236, v134
    v_mul_f32 v237, v237, v135
    v_exp_f32 v236, v236
    v_exp_f32 v237, v237
    v_mul_f32 v142, v134, v142
    v_fma_f32 v236, v236, v5, v5
    v_fma_f32 v237, v237, v5, v5
    v_mfma_f32_32x32x16_bf16 v[32:47], a[172:175], a[84:87], v[32:47]
    s_waitcnt vmcnt(8)
    v_rcp_f32 v236, v236
    v_rcp_f32 v237, v237
    v_mul_f32 v143, v135, v143
    v_mul_f32 v236, v236, v142
    v_mul_f32 v237, v237, v143
    v_cvt_pk_bf16_f32 v243, v236, v237
    v_mfma_f32_32x32x16_bf16 v[16:31], a[176:179], a[88:91], v[16:31]
    s_waitcnt vmcnt(6)
    v_xor_b32 v15, s66, v15
    v_lshlrev_b32 v15, 1, v15
    v_cmp_ne_u32 s[92:93], 0, v15
    s_cmp_lg_u64 s[92:93], 0
    s_cbranch_scc1 L_x3f_spin_44
L_x3f_ok_45:
    s_cbranch_vccnz L_far_46
    buffer_store_dwordx4 v[240:243], v1, s[24:27], s94 offen
L_back_47:
    v_mul_f32 v236, v144, v144
    v_mul_f32 v237, v145, v145
    v_fma_f32 v236, v236, v245, v244
    v_fma_f32 v237, v237, v245, v244
    v_mul_f32 v236, v236, v144
    v_mul_f32 v237, v237, v145
    v_mfma_f32_32x32x16_bf16 v[32:47], a[180:183], a[88:91], v[32:47]
    v_cmp_ne_u32 s[92:93], s66, v14
    s_cmp_lg_u64 s[92:93], 0
    s_cbranch_scc1 L_x3_1_spin_48
L_x3_1_ok_49:
    buffer_load_dwordx4 v[80:83], v246, s[24:27], s78 offen offset:0 sc1
    v_exp_f32 v236, v236
    v_exp_f32 v237, v237
    v_mul_f32 v152, v144, v152
    v_fma_f32 v236, v236, v13, v13
    v_fma_f32 v237, v237, v13, v13
    v_rcp_f32 v236, v236
    v_mfma_f32_32x32x16_bf16 v[16:31], a[184:187], a[92:95], v[16:31]
    buffer_load_dwordx4 v[84:87], v246, s[24:27], s79 offen offset:0 sc1
    v_rcp_f32 v237, v237
    v_mul_f32 v153, v145, v153
    v_mul_f32 v236, v236, v152
    v_mul_f32 v237, v237, v153
    v_cvt_pk_bf16_f32 v240, v236, v237
    v_mul_f32 v236, v146, v146
    v_mul_f32 v237, v147, v147
    v_fma_f32 v236, v236, v245, v244
    v_fma_f32 v237, v237, v245, v244
    v_mfma_f32_32x32x16_bf16 v[32:47], a[188:191], a[92:95], v[32:47]
    s_waitcnt vmcnt(8)
    buffer_load_dwordx4 v[88:91], v246, s[24:27], s80 offen offset:0 sc1
    v_mul_f32 v236, v236, v146
    v_mul_f32 v237, v237, v147
    v_exp_f32 v236, v236
    v_exp_f32 v237, v237
    v_mul_f32 v154, v146, v154
    v_fma_f32 v236, v236, v13, v13
    v_fma_f32 v237, v237, v13, v13
    v_mfma_f32_32x32x16_bf16 v[16:31], a[192:195], a[96:99], v[16:31]
    buffer_load_dwordx4 v[92:95], v246, s[24:27], s81 offen offset:0 sc1
    v_rcp_f32 v236, v236
    v_rcp_f32 v237, v237
    v_mul_f32 v155, v147, v155
    v_mul_f32 v236, v236, v154
    v_mul_f32 v237, v237, v155
    v_cvt_pk_bf16_f32 v241, v236, v237
    v_mul_f32 v236, v148, v148
    v_mul_f32 v237, v149, v149
    v_mfma_f32_32x32x16_bf16 v[32:47], a[196:199], a[96:99], v[32:47]
    s_waitcnt vmcnt(9)
    buffer_load_dwordx4 v[96:99], v246, s[24:27], s82 offen offset:0 sc1
    v_fma_f32 v236, v236, v245, v244
    v_fma_f32 v237, v237, v245, v244
    v_mul_f32 v236, v236, v148
    v_mul_f32 v237, v237, v149
    v_exp_f32 v236, v236
    v_exp_f32 v237, v237
    v_mul_f32 v156, v148, v156
    v_fma_f32 v236, v236, v13, v13
    v_mfma_f32_32x32x16_bf16 v[16:31], a[200:203], a[100:103], v[16:31]
    v_fma_f32 v237, v237, v13, v13
    v_rcp_f32 v236, v236
    v_rcp_f32 v237, v237
    v_mul_f32 v157, v149, v157
    v_mul_f32 v236, v236, v156
    v_mul_f32 v237, v237, v157
    v_cvt_pk_bf16_f32 v242, v236, v237
    v_mul_f32 v236, v150, v150
    v_mfma_f32_32x32x16_bf16 v[32:47], a[204:207], a[100:103], v[32:47]
    s_waitcnt vmcnt(8)
    buffer_load_dwordx4 v[100:103], v246, s[24:27], s83 offen offset:0 sc1
    v_mul_f32 v237, v151, v151
    v_fma_f32 v236, v236, v245, v244
    v_fma_f32 v237, v237, v245, v244
    v_mul_f32 v236, v236, v150
    v_mul_f32 v237, v237, v151
    v_exp_f32 v236, v236
    v_exp_f32 v237, v237
    v_mul_f32 v158, v150, v158
    v_mfma_f32_32x32x16_bf16 v[16:31], a[208:211], a[104:107], v[16:31]
    s_waitcnt vmcnt(6)
    s_cbranch_vccnz L_far_50
    buffer_store_dword v4, v2, s[24:27], s20 offen offset:1536
L_back_51:
    v_fma_f32 v236, v236, v13, v13
    v_fma_f32 v237, v237, v13, v13
    v_rcp_f32 v236, v236
    v_rcp_f32 v237, v237
    v_mul_f32 v159, v151, v159
    v_mul_f32 v236, v236, v158
    v_mul_f32 v237, v237, v159
    v_cvt_pk_bf16_f32 v243, v236, v237
    v_mfma_f32_32x32x16_bf16 v[32:47], a[212:215], a[104:107], v[32:47]
    buffer_load_dwordx4 v[104:107], v246, s[24:27], s84 offen offset:0 sc1
    s_cbranch_vccnz L_far_52
    buffer_store_dwordx4 v[240:243], v1, s[24:27], s95 offen
L_back_53:
    v_and_b32 v224, 31, v0
    v_mul_u32_u24 v224, 896, v224
    v_lshrrev_b32 v8, 5, v0
    v_lshl_add_u32 v224, v8, 4, v224
    s_xor_b32 s72, s61, 1
    s_mul_i32 s72, s72, 12288
    s_add_u32 s72, s72, 114688
    v_mfma_f32_32x32x16_bf16 v[16:31], a[216:219], a[108:111], v[16:31]
    buffer_load_dword v14, v12, s[24:27], 0 offen offset:1024 sc1
    v_add_u32 v9, s72, v1
    s_xor_b32 s72, s61, 2
    s_mul_i32 s72, s72, 12288
    s_add_u32 s72, s72, 116736
    v_mfma_f32_32x32x16_bf16 v[32:47], a[220:223], a[108:111], v[32:47]
    s_waitcnt vmcnt(9)
    buffer_load_dwordx4 v[108:111], v246, s[24:27], s78 offen offset:1024 sc1
    v_add_u32 v10, s72, v1
    s_xor_b32 s72, s61, 3
    s_mul_i32 s72, s72, 12288
    s_add_u32 s72, s72, 118784
    v_mfma_f32_32x32x16_bf16 v[48:63], a[112:115], v[80:83], 0
    v_add_u32 v11, s72, v1
    s_mul_i32 s72, s61, 12288
    s_add_u32 s72, s72, 114688
    v_add_u32 v8, s72, v1
    v_accvgpr_read_b32 v193, a248
    v_mfma_f32_32x32x16_bf16 v[64:79], a[116:119], v[80:83], 0
    s_waitcnt vmcnt(9)
    buffer_load_dwordx4 v[112:115], v246, s[24:27], s79 offen offset:1024 sc1
    v_accvgpr_read_b32 v195, a249
    v_accvgpr_read_b32 v197, a250
    v_accvgpr_read_b32 v199, a251
    v_lshlrev_b32 v192, 16, v193
    v_mfma_f32_32x32x16_bf16 v[48:63], a[120:123], v[84:87], v[48:63]
    v_and_b32 v193, s77, v193
    v_lshlrev_b32 v194, 16, v195
    v_and_b32 v195, s77, v195
    v_lshlrev_b32 v196, 16, v197
    v_and_b32 v197, s77, v197
    v_mfma_f32_32x32x16_bf16 v[64:79], a[124:127], v[84:87], v[64:79]
    s_waitcnt vmcnt(9)
    buffer_load_dwordx4 v[116:119], v246, s[24:27], s80 offen offset:1024 sc1
    v_lshlrev_b32 v198, 16, v199
    v_and_b32 v199, s77, v199
    v_mfma_f32_32x32x16_bf16 v[48:63], a[128:131], v[88:91], v[48:63]
    v_mfma_f32_32x32x16_bf16 v[64:79], a[132:135], v[88:91], v[64:79]
    s_waitcnt vmcnt(9)
    buffer_load_dwordx4 v[120:123], v246, s[24:27], s81 offen offset:1024 sc1
    v_mfma_f32_32x32x16_bf16 v[48:63], a[136:139], v[92:95], v[48:63]
    v_mfma_f32_32x32x16_bf16 v[64:79], a[140:143], v[92:95], v[64:79]
    s_waitcnt vmcnt(9)
    buffer_load_dwordx4 v[124:127], v246, s[24:27], s82 offen offset:1024 sc1
    v_mfma_f32_32x32x16_bf16 v[48:63], a[144:147], v[96:99], v[48:63]
    v_mfma_f32_32x32x16_bf16 v[64:79], a[148:151], v[96:99], v[64:79]
    s_waitcnt vmcnt(9)
    buffer_load_dwordx4 a[56:59], v246, s[24:27], s83 offen offset:1024 sc1
    v_mfma_f32_32x32x16_bf16 v[48:63], a[152:155], v[100:103], v[48:63]
    v_xor_b32 v4, 0x80000000, v4
    s_waitcnt vmcnt(7)
    s_cbranch_vccnz L_far_54
    buffer_store_dword v4, v2, s[24:27], s20 offen offset:0
L_back_55:
    v_mfma_f32_32x32x16_bf16 v[64:79], a[156:159], v[100:103], v[64:79]
    buffer_load_dwordx4 a[60:63], v246, s[24:27], s84 offen offset:1024 sc1
    v_mfma_f32_32x32x16_bf16 v[48:63], a[160:163], v[104:107], v[48:63]
    s_waitcnt vmcnt(8)
    v_cmp_ne_u32 s[92:93], s66, v14
    s_cmp_lg_u64 s[92:93], 0
    s_cbranch_scc1 L_x3_2_spin_56
L_x3_2_ok_57:
    v_mfma_f32_32x32x16_bf16 v[64:79], a[164:167], v[104:107], v[64:79]
    s_waitcnt vmcnt(7)
    buffer_load_dwordx4 a[64:67], v1, s[24:27], s78 offen offset:2048 sc1
    v_mfma_f32_32x32x16_bf16 v[48:63], a[168:171], v[108:111], v[48:63]
    buffer_load_dwordx4 a[68:71], v1, s[24:27], s79 offen offset:2048 sc1
    v_mfma_f32_32x32x16_bf16 v[64:79], a[172:175], v[108:111], v[64:79]
    s_waitcnt vmcnt(8)
    buffer_load_dwordx4 a[72:75], v1, s[24:27], s80 offen offset:2048 sc1
    v_mfma_f32_32x32x16_bf16 v[48:63], a[176:179], v[112:115], v[48:63]
    buffer_load_dword v14, v12, s[24:27], 0 offen offset:1536 sc1
    v_mfma_f32_32x32x16_bf16 v[64:79], a[180:183], v[112:115], v[64:79]
    s_waitcnt vmcnt(9)
    buffer_load_dwordx4 a[76:79], v1, s[24:27], s81 offen offset:2048 sc1
    v_mfma_f32_32x32x16_bf16 v[48:63], a[184:187], v[116:119], v[48:63]
L_hop_5:
    s_cbranch_execz L_hop_out
    v_mfma_f32_32x32x16_bf16 v[64:79], a[188:191], v[116:119], v[64:79]
    s_waitcnt vmcnt(9)
    buffer_load_dwordx4 a[80:83], v1, s[24:27], s82 offen offset:2048 sc1
    v_mfma_f32_32x32x16_bf16 v[48:63], a[192:195], v[120:123], v[48:63]
    v_mfma_f32_32x32x16_bf16 v[64:79], a[196:199], v[120:123], v[64:79]
    s_waitcnt vmcnt(9)
    buffer_load_dwordx4 a[84:87], v1, s[24:27], s83 offen offset:2048 sc1
    v_mfma_f32_32x32x16_bf16 v[48:63], a[200:203], v[124:127], v[48:63]
    v_mfma_f32_32x32x16_bf16 v[64:79], a[204:207], v[124:127], v[64:79]
    s_waitcnt vmcnt(9)
    buffer_load_dwordx4 a[88:91], v1, s[24:27], s84 offen offset:2048 sc1
    v_mfma_f32_32x32x16_bf16 v[48:63], a[208:211], a[56:59], v[48:63]
    v_mfma_f32_32x32x16_bf16 v[64:79], a[212:215], a[56:59], v[64:79]
    s_waitcnt vmcnt(8)
    v_mfma_f32_32x32x16_bf16 v[48:63], a[216:219], a[60:63], v[48:63]
    v_mfma_f32_32x32x16_bf16 v[64:79], a[220:223], a[60:63], v[64:79]
    s_waitcnt vmcnt(7)
    s_waitcnt vmcnt(4)
    v_cmp_ne_u32 s[92:93], s66, v14
    s_cmp_lg_u64 s[92:93], 0
    s_cbranch_scc1 L_x3_3_spin_58
L_x3_3_ok_59:
    buffer_load_dwordx4 a[92:95], v1, s[24:27], s96 offen offset:0 sc1
    v_mfma_f32_32x32x16_bf16 v[16:31], a[224:227], a[64:67], v[16:31]
    buffer_load_dwordx4 a[96:99], v1, s[24:27], s96 offen offset:1024 sc1
    v_mfma_f32_32x32x16_bf16 v[32:47], a[228:231], a[64:67], v[32:47]
    buffer_load_dwordx4 a[100:103], v1, s[24:27], s96 offen offset:2048 sc1
    v_mfma_f32_32x32x16_bf16 v[16:31], a[232:235], a[68:71], v[16:31]
    buffer_load_dwordx4 a[104:107], v1, s[24:27], s96 offen offset:3072 sc1
    v_mfma_f32_32x32x16_bf16 v[32:47], a[236:239], a[68:71], v[32:47]
    buffer_load_dword v14, v12, s[24:27], 0 offen offset:0 sc1
    v_mfma_f32_32x32x16_bf16 v[16:31], a[240:243], a[72:75], v[16:31]
    v_mfma_f32_32x32x16_bf16 v[32:47], a[244:247], a[72:75], v[32:47]
    s_waitcnt vmcnt(8)
    buffer_load_dwordx4 a[108:111], v3, s[24:27], s96 offen offset:0 sc1
    v_mfma_f32_32x32x16_bf16 v[16:31], a[0:3], a[76:79], v[16:31]
    buffer_load_dwordx4 v[80:83], v3, s[24:27], s96 offen offset:1024 sc1
    v_mfma_f32_32x32x16_bf16 v[32:47], a[4:7], a[76:79], v[32:47]
    s_waitcnt vmcnt(9)
    v_mfma_f32_32x32x16_bf16 v[16:31], a[8:11], a[80:83], v[16:31]
    buffer_load_dwordx4 v[84:87], v3, s[24:27], s96 offen offset:2048 sc1
    v_mfma_f32_32x32x16_bf16 v[32:47], a[12:15], a[80:83], v[32:47]
    s_waitcnt vmcnt(9)
    v_mfma_f32_32x32x16_bf16 v[16:31], a[16:19], a[84:87], v[16:31]
    buffer_load_dwordx4 v[88:91], v246, s[24:27], s78 offen offset:2048 sc1
    v_mfma_f32_32x32x16_bf16 v[32:47], a[20:23], a[84:87], v[32:47]
    s_waitcnt vmcnt(9)
    v_mfma_f32_32x32x16_bf16 v[16:31], a[24:27], a[88:91], v[16:31]
    buffer_load_dwordx4 v[92:95], v246, s[24:27], s79 offen offset:2048 sc1
    v_mfma_f32_32x32x16_bf16 v[32:47], a[28:31], a[88:91], v[32:47]
    s_waitcnt vmcnt(9)
    v_mfma_f32_32x32x16_bf16 v[16:31], a[32:35], a[92:95], v[16:31]
    buffer_load_dwordx4 v[96:99], v246, s[24:27], s80 offen offset:2048 sc1
    v_mfma_f32_32x32x16_bf16 v[32:47], v[160:163], a[92:95], v[32:47]
    s_waitcnt vmcnt(9)
    v_mfma_f32_32x32x16_bf16 v[16:31], a[36:39], a[96:99], v[16:31]
    buffer_load_dwordx4 v[100:103], v246, s[24:27], s81 offen offset:2048 sc1
    v_mfma_f32_32x32x16_bf16 v[32:47], v[164:167], a[96:99], v[32:47]
    s_waitcnt vmcnt(9)
    v_mfma_f32_32x32x16_bf16 v[16:31], v[168:171], a[100:103], v[16:31]
    buffer_load_dwordx4 v[104:107], v246, s[24:27], s82 offen offset:2048 sc1
    v_mfma_f32_32x32x16_bf16 v[32:47], v[172:175], a[100:103], v[32:47]
    s_waitcnt vmcnt(9)
    s_waitcnt vmcnt(8)
    v_xor_b32 v14, 0x80000000, v14
    v_cmp_ne_u32 s[92:93], s66, v14
    s_cmp_lg_u64 s[92:93], 0
    s_cbranch_scc1 L_x3_4_spin_60
L_x3_4_ok_61:
    v_mfma_f32_32x32x16_bf16 v[16:31], v[176:179], a[104:107], v[16:31]
    buffer_load_dwordx4 v[108:111], v246, s[24:27], s83 offen offset:2048 sc1
    v_mfma_f32_32x32x16_bf16 v[32:47], v[180:183], a[104:107], v[32:47]
    s_waitcnt vmcnt(8)
    buffer_load_dwordx4 v[112:115], v246, s[24:27], s84 offen offset:2048 sc1
    v_mfma_f32_32x32x16_bf16 v[16:31], v[184:187], a[108:111], v[16:31]
    v_mfma_f32_32x32x16_bf16 v[32:47], v[188:191], a[108:111], v[32:47]
    s_waitcnt vmcnt(8)
    buffer_load_dwordx4 v[116:119], v1, s[24:27], s97 offen offset:0 sc1
    v_mfma_f32_32x32x16_bf16 v[16:31], a[40:43], v[80:83], v[16:31]
    v_mfma_f32_32x32x16_bf16 v[32:47], a[44:47], v[80:83], v[32:47]
    s_waitcnt vmcnt(8)
    buffer_load_dwordx4 v[120:123], v1, s[24:27], s97 offen offset:1024 sc1
    v_mfma_f32_32x32x16_bf16 v[16:31], a[48:51], v[84:87], v[16:31]
    v_mfma_f32_32x32x16_bf16 v[32:47], a[52:55], v[84:87], v[32:47]
    s_waitcnt vmcnt(8)
    buffer_load_dwordx4 v[124:127], v1, s[24:27], s97 offen offset:2048 sc1
    v_mfma_f32_32x32x16_bf16 v[48:63], a[224:227], v[88:91], v[48:63]
    v_mfma_f32_32x32x16_bf16 v[64:79], a[228:231], v[88:91], v[64:79]
    s_waitcnt vmcnt(8)
    buffer_load_dwordx4 a[56:59], v1, s[24:27], s97 offen offset:3072 sc1
    v_mfma_f32_32x32x16_bf16 v[48:63], a[232:235], v[92:95], v[48:63]
    s_nop 8
    v_mfma_f32_32x32x16_bf16 v[64:79], a[236:239], v[92:95], v[64:79]
    s_waitcnt vmcnt(8)
    buffer_load_dwordx4 a[60:63], v3, s[24:27], s97 offen offset:0 sc1
    ds_write_b128 v9, v[32:35] offset:0
    v_mfma_f32_32x32x16_bf16 v[48:63], a[240:243], v[96:99], v[48:63]
    ds_write_b128 v9, v[36:39] offset:1024
    v_mfma_f32_32x32x16_bf16 v[64:79], a[244:247], v[96:99], v[64:79]
    s_waitcnt vmcnt(8)
    buffer_load_dwordx4 a[64:67], v3, s[24:27], s97 offen offset:1024 sc1
    ds_write_b128 v10, v[24:27] offset:0
    v_mfma_f32_32x32x16_bf16 v[48:63], a[0:3], v[100:103], v[48:63]
    ds_write_b128 v10, v[28:31] offset:1024
    v_mfma_f32_32x32x16_bf16 v[64:79], a[4:7], v[100:103], v[64:79]
    s_waitcnt vmcnt(8)
    buffer_load_dwordx4 a[68:71], v3, s[24:27], s97 offen offset:2048 sc1
    ds_write_b128 v11, v[40:43] offset:0
    v_mfma_f32_32x32x16_bf16 v[48:63], a[8:11], v[104:107], v[48:63]
    ds_write_b128 v11, v[44:47] offset:1024
    v_add_f32 v16, v16, v192
    v_add_f32 v17, v17, v193
    v_mfma_f32_32x32x16_bf16 v[64:79], a[12:15], v[104:107], v[64:79]
    s_waitcnt vmcnt(8)
    v_add_f32 v18, v18, v194
    v_add_f32 v19, v19, v195
    v_add_f32 v20, v20, v196
    v_add_f32 v21, v21, v197
    v_add_f32 v22, v22, v198
    v_mfma_f32_32x32x16_bf16 v[48:63], a[16:19], v[108:111], v[48:63]
    v_add_f32 v23, v23, v199
    s_waitcnt lgkmcnt(0)
    s_barrier
    v_mfma_f32_32x32x16_bf16 v[64:79], a[20:23], v[108:111], v[64:79]
    s_waitcnt vmcnt(7)
    ds_read_b128 v[200:203], v8 offset:0
    ds_read_b128 v[204:207], v8 offset:1024
    ds_read_b128 v[208:211], v8 offset:2048
    v_mfma_f32_32x32x16_bf16 v[48:63], a[24:27], v[112:115], v[48:63]
    ds_read_b128 v[212:215], v8 offset:3072
    ds_read_b128 v[216:219], v8 offset:4096
    ds_read_b128 v[220:223], v8 offset:5120
    v_accvgpr_read_b32 v193, a252
    v_accvgpr_read_b32 v195, a253
    v_mfma_f32_32x32x16_bf16 v[64:79], a[28:31], v[112:115], v[64:79]
    s_waitcnt vmcnt(6)
    v_accvgpr_read_b32 v197, a254
    v_accvgpr_read_b32 v199, a255
    v_lshlrev_b32 v192, 16, v193
    v_and_b32 v193, s77, v193
    v_lshlrev_b32 v194, 16, v195
    v_mfma_f32_32x32x16_bf16 v[48:63], a[32:35], v[116:119], v[48:63]
    v_and_b32 v195, s77, v195
    v_lshlrev_b32 v196, 16, v197
    v_and_b32 v197, s77, v197
    v_lshlrev_b32 v198, 16, v199
    v_and_b32 v199, s77, v199
    v_mfma_f32_32x32x16_bf16 v[64:79], v[160:163], v[116:119], v[64:79]
    s_waitcnt vmcnt(5)
    s_waitcnt lgkmcnt(0)
    v_add_f32 v16, v16, v200
    v_add_f32 v17, v17, v201
    v_mfma_f32_32x32x16_bf16 v[48:63], a[36:39], v[120:123], v[48:63]
    v_add_f32 v18, v18, v202
    v_add_f32 v19, v19, v203
    v_add_f32 v20, v20, v204
    v_add_f32 v21, v21, v205
    v_add_f32 v22, v22, v206
    v_mfma_f32_32x32x16_bf16 v[64:79], v[164:167], v[120:123], v[64:79]
    s_waitcnt vmcnt(4)
    v_add_f32 v23, v23, v207
    v_add_f32 v16, v16, v208
    v_add_f32 v17, v17, v209
    v_add_f32 v18, v18, v210
    v_add_f32 v19, v19, v211
    v_mfma_f32_32x32x16_bf16 v[48:63], v[168:171], v[124:127], v[48:63]
    v_add_f32 v20, v20, v212
    v_add_f32 v21, v21, v213
    v_add_f32 v22, v22, v214
    v_add_f32 v23, v23, v215
    v_add_f32 v16, v16, v216
    v_mfma_f32_32x32x16_bf16 v[64:79], v[172:175], v[124:127], v[64:79]
    s_waitcnt vmcnt(3)
    v_add_f32 v17, v17, v217
    v_add_f32 v18, v18, v218
    v_add_f32 v19, v19, v219
    v_add_f32 v20, v20, v220
    v_add_f32 v21, v21, v221
    s_waitcnt vmcnt(0)
    v_mfma_f32_32x32x16_bf16 v[64:79], v[180:183], a[56:59], v[64:79]
    v_add_f32 v22, v22, v222
    v_add_f32 v23, v23, v223
    v_cvt_pk_bf16_f32 v228, v16, v17
    v_cvt_pk_bf16_f32 v229, v18, v19
    v_cvt_pk_bf16_f32 v230, v20, v21
    v_cvt_pk_bf16_f32 v231, v22, v23
    v_mfma_f32_32x32x16_bf16 v[64:79], v[188:191], a[60:63], v[64:79]
    buffer_store_dwordx4 v[228:231], v224, s[48:51], s23 offen
    s_add_u32 s23, s23, 114688
    v_mfma_f32_32x32x16_bf16 v[64:79], a[44:47], a[64:67], v[64:79]
    v_mfma_f32_32x32x16_bf16 v[64:79], a[52:55], a[68:71], v[64:79]
    v_mfma_f32_32x32x16_bf16 v[48:63], v[176:179], a[56:59], v[48:63]
    v_mfma_f32_32x32x16_bf16 v[48:63], v[184:187], a[60:63], v[48:63]
    v_mfma_f32_32x32x16_bf16 v[48:63], a[40:43], a[64:67], v[48:63]
    s_nop 8
    ds_write_b128 v9, v[64:67] offset:6144
    ds_write_b128 v9, v[68:71] offset:7168
    v_mfma_f32_32x32x16_bf16 v[48:63], a[48:51], a[68:71], v[48:63]
    ds_write_b128 v11, v[72:75] offset:6144
    ds_write_b128 v11, v[76:79] offset:7168
    s_nop 9
    ds_write_b128 v10, v[56:59] offset:6144
    ds_write_b128 v10, v[60:63] offset:7168
    v_pk_add_f32 v[48:49], v[48:49], v[192:193]
    v_pk_add_f32 v[50:51], v[50:51], v[194:195]
    v_pk_add_f32 v[52:53], v[52:53], v[196:197]
    v_pk_add_f32 v[54:55], v[54:55], v[198:199]
    s_waitcnt lgkmcnt(0)
    s_barrier
    ds_read_b128 v[200:203], v8 offset:6144
    ds_read_b128 v[204:207], v8 offset:7168
    ds_read_b128 v[208:211], v8 offset:8192
    ds_read_b128 v[212:215], v8 offset:9216
    ds_read_b128 v[216:219], v8 offset:10240
    ds_read_b128 v[220:223], v8 offset:11264
    s_waitcnt lgkmcnt(4)
    v_pk_add_f32 v[48:49], v[48:49], v[200:201]
    v_pk_add_f32 v[50:51], v[50:51], v[202:203]
    v_pk_add_f32 v[52:53], v[52:53], v[204:205]
    v_pk_add_f32 v[54:55], v[54:55], v[206:207]
    s_waitcnt lgkmcnt(2)
    v_pk_add_f32 v[48:49], v[48:49], v[208:209]
    v_pk_add_f32 v[50:51], v[50:51], v[210:211]
    v_pk_add_f32 v[52:53], v[52:53], v[212:213]
    v_pk_add_f32 v[54:55], v[54:55], v[214:215]
    s_waitcnt lgkmcnt(0)
    v_pk_add_f32 v[48:49], v[48:49], v[216:217]
    v_pk_add_f32 v[50:51], v[50:51], v[218:219]
    v_pk_add_f32 v[52:53], v[52:53], v[220:221]
    v_pk_add_f32 v[54:55], v[54:55], v[222:223]
    v_cvt_pk_bf16_f32 v232, v48, v49
    v_cvt_pk_bf16_f32 v233, v50, v51
    v_cvt_pk_bf16_f32 v234, v52, v53
    v_cvt_pk_bf16_f32 v235, v54, v55
    buffer_store_dwordx4 v[232:235], v224, s[48:51], s23 offen
    s_endpgm
L_help:
    s_waitcnt vmcnt(0)
    s_cbranch_vccnz L_far_62
    buffer_store_dword v4, v2, s[52:55], s16 offen offset:64
L_back_63:
    s_cmp_lg_u32 s60, 31
    s_cbranch_scc1 L_help_tag
    s_lshl_b32 s72, s61, 13
    s_add_u32 s72, s72, 4096
    v_lshl_add_u32 v7, v0, 7, s72
    s_mov_b32 s91, 0
L_all_64:
    buffer_load_dword v8, v7, s[24:27], 0 offen offset:0 sc1
    s_waitcnt vmcnt(0)
    v_cmp_ne_u32 vcc, s66, v8
    s_add_u32 s91, s91, 1
    s_cbranch_vccz L_all_ok_65
    s_cmp_lt_u32 s91, 400000
    s_cbranch_scc1 L_all_64
L_all_ok_65:
    s_barrier
    buffer_store_dword v4, v2, s[52:55], 0 offen sc1
L_help_tag:
L_help_end:
    s_endpgm
L_x1g0_spin_8:
    s_mov_b64 s[92:93], vcc
    s_mov_b32 s91, 0
L_x1g0_66:
    s_sleep 4
    buffer_load_dword v224, v229, s[24:27], 0 offen offset:0 sc1
    s_waitcnt vmcnt(0)
    v_cmp_ne_u32 vcc, s66, v224
    s_add_u32 s91, s91, 1
    s_cbranch_vccz L_x1g0_ok_67
    s_cmp_lt_u32 s91, 400000
    s_cbranch_scc1 L_x1g0_66
L_x1g0_ok_67:
    s_mov_b64 vcc, s[92:93]
    s_branch L_x1g0_ok_9
L_x1g1_spin_10:
    s_mov_b64 s[92:93], vcc
    s_mov_b32 s91, 0
L_x1g1_68:
    s_sleep 4
    buffer_load_dword v225, v230, s[24:27], 0 offen offset:0 sc1
    s_waitcnt vmcnt(0)
    v_cmp_ne_u32 vcc, s66, v225
    s_add_u32 s91, s91, 1
    s_cbranch_vccz L_x1g1_ok_69
    s_cmp_lt_u32 s91, 400000
    s_cbranch_scc1 L_x1g1_68
L_x1g1_ok_69:
    s_mov_b64 vcc, s[92:93]
    s_branch L_x1g1_ok_11
L_x2a_spin_16:
    s_mov_b64 s[92:93], vcc
    s_mov_b32 s91, 0
L_x2a_70:
    buffer_load_dword v224, v246, s[24:27], 0 offen offset:0 sc1
    s_waitcnt vmcnt(0)
    v_cmp_ne_u32 vcc, s66, v224
    s_add_u32 s91, s91, 1
    s_cbranch_vccz L_x2a_ok_71
    s_cmp_lt_u32 s91, 400000
    s_cbranch_scc1 L_x2a_70
L_x2a_ok_71:
    s_mov_b64 vcc, s[92:93]
    s_branch L_x2a_ok_17
L_x2c_spin_20:
    s_mov_b64 s[92:93], vcc
    s_mov_b32 s91, 0
L_x2c_72:
    buffer_load_dword v224, v252, s[24:27], 0 offen offset:640 sc1
    s_waitcnt vmcnt(0)
    v_cmp_ne_u32 vcc, s66, v224
    s_add_u32 s91, s91, 1
    s_cbranch_vccz L_x2c_ok_73
    s_cmp_lt_u32 s91, 400000
    s_cbranch_scc1 L_x2c_72
L_x2c_ok_73:
    s_mov_b64 vcc, s[92:93]
    s_branch L_x2c_ok_21
L_x2b_spin_32:
    s_mov_b64 s[92:93], vcc
    s_mov_b32 s91, 0
L_x2b_74:
    buffer_load_dword v14, v13, s[24:27], 0 offen offset:0 sc1
    s_waitcnt vmcnt(0)
    v_cmp_ne_u32 vcc, s66, v14
    s_add_u32 s91, s91, 1
    s_cbranch_vccz L_x2b_ok_75
    s_cmp_lt_u32 s91, 400000
    s_cbranch_scc1 L_x2b_74
L_x2b_ok_75:
    s_mov_b64 vcc, s[92:93]
    s_branch L_x2b_ok_33
L_x2d_spin_34:
    s_mov_b64 s[92:93], vcc
    s_mov_b32 s91, 0
L_x2d_76:
    buffer_load_dword v14, v13, s[24:27], 0 offen offset:64 sc1
    s_waitcnt vmcnt(0)
    v_cmp_ne_u32 vcc, s66, v14
    s_add_u32 s91, s91, 1
    s_cbranch_vccz L_x2d_ok_77
    s_cmp_lt_u32 s91, 400000
    s_cbranch_scc1 L_x2d_76
L_x2d_ok_77:
    s_mov_b64 vcc, s[92:93]
    s_branch L_x2d_ok_35
L_x3_0_spin_40:
    s_mov_b64 s[92:93], vcc
    s_mov_b32 s91, 0
L_x3_0_78:
    buffer_load_dword v14, v12, s[24:27], 0 offen offset:0 sc1
    s_waitcnt vmcnt(0)
    v_xor_b32 v14, s66, v14
    v_lshlrev_b32 v14, 1, v14
    v_cmp_ne_u32 vcc, 0, v14
    s_add_u32 s91, s91, 1
    s_cbranch_vccz L_x3_0_ok_79
    s_cmp_lt_u32 s91, 400000
    s_cbranch_scc1 L_x3_0_78
L_x3_0_ok_79:
    s_mov_b64 vcc, s[92:93]
    s_branch L_x3_0_ok_41
L_x3f_spin_44:
    s_mov_b64 s[92:93], vcc
    s_mov_b32 s91, 0
L_x3f_80:
    buffer_load_dword v15, v247, s[24:27], 0 offen offset:0 sc1
    s_waitcnt vmcnt(0)
    v_xor_b32 v15, s66, v15
    v_lshlrev_b32 v15, 1, v15
    v_cmp_ne_u32 vcc, 0, v15
    s_add_u32 s91, s91, 1
    s_cbranch_vccz L_x3f_ok_81
    s_cmp_lt_u32 s91, 400000
    s_cbranch_scc1 L_x3f_80
L_x3f_ok_81:
    s_mov_b64 vcc, s[92:93]
    s_branch L_x3f_ok_45
L_x3_1_spin_48:
    s_mov_b64 s[92:93], vcc
    s_mov_b32 s91, 0
L_x3_1_82:
    buffer_load_dword v14, v12, s[24:27], 0 offen offset:512 sc1
    s_waitcnt vmcnt(0)
    v_cmp_ne_u32 vcc, s66, v14
    s_add_u32 s91, s91, 1
    s_cbranch_vccz L_x3_1_ok_83
    s_cmp_lt_u32 s91, 400000
    s_cbranch_scc1 L_x3_1_82
L_x3_1_ok_83:
    s_mov_b64 vcc, s[92:93]
    s_branch L_x3_1_ok_49
L_x3_2_spin_56:
    s_mov_b64 s[92:93], vcc
    s_mov_b32 s91, 0
L_x3_2_84:
    buffer_load_dword v14, v12, s[24:27], 0 offen offset:1024 sc1
    s_waitcnt vmcnt(0)
    v_cmp_ne_u32 vcc, s66, v14
    s_add_u32 s91, s91, 1
    s_cbranch_vccz L_x3_2_ok_85
    s_cmp_lt_u32 s91, 400000
    s_cbranch_scc1 L_x3_2_84
L_x3_2_ok_85:
    s_mov_b64 vcc, s[92:93]
    s_branch L_x3_2_ok_57
L_x3_3_spin_58:
    s_mov_b64 s[92:93], vcc
    s_mov_b32 s91, 0
L_x3_3_86:
    buffer_load_dword v14, v12, s[24:27], 0 offen offset:1536 sc1
    s_waitcnt vmcnt(0)
    v_cmp_ne_u32 vcc, s66, v14
    s_add_u32 s91, s91, 1
    s_cbranch_vccz L_x3_3_ok_87
    s_cmp_lt_u32 s91, 400000
    s_cbranch_scc1 L_x3_3_86
L_x3_3_ok_87:
    s_mov_b64 vcc, s[92:93]
    s_branch L_x3_3_ok_59
L_x3_4_spin_60:
    s_mov_b64 s[92:93], vcc
    s_mov_b32 s91, 0
L_x3_4_88:
    buffer_load_dword v14, v12, s[24:27], 0 offen offset:0 sc1
    s_waitcnt vmcnt(0)
    v_xor_b32 v14, 0x80000000, v14
    v_cmp_ne_u32 vcc, s66, v14
    s_add_u32 s91, s91, 1
    s_cbranch_vccz L_x3_4_ok_89
    s_cmp_lt_u32 s91, 400000
    s_cbranch_scc1 L_x3_4_88
L_x3_4_ok_89:
    s_mov_b64 vcc, s[92:93]
    s_branch L_x3_4_ok_61
L_far_12:
    buffer_store_dwordx2 v[144:145], v244, s[24:27], s9 offen offset:0 sc1
    buffer_store_dwordx2 v[146:147], v244, s[24:27], s9 offen offset:128 sc1
    buffer_store_dwordx2 v[148:149], v244, s[24:27], s9 offen offset:256 sc1
    s_mov_b32 exec_hi, 0
    buffer_store_dwordx2 v[150:151], v244, s[24:27], s9 offen offset:384 sc1
    s_branch L_back_13
L_far_14:
    buffer_store_dword v4, v2, s[24:27], s10 offen sc1
    s_branch L_back_15
L_far_18:
    buffer_store_dword v4, v2, s[52:55], s5 offen offset:640 sc1
    s_branch L_back_19
L_far_22:
    buffer_store_dwordx4 v[48:51], v1, s[32:35], s14 offen offset:0 sc1
    s_branch L_back_23
L_far_24:
    buffer_store_dwordx4 v[52:55], v1, s[32:35], s14 offen offset:1024 sc1
    s_branch L_back_25
L_far_26:
    buffer_store_dword v4, v2, s[24:27], s16 offen sc1
    s_branch L_back_27
L_far_28:
    buffer_store_dword v56, v1, s[52:55], s15 offen sc1
    s_branch L_back_29
L_far_30:
    buffer_store_dword v4, v2, s[52:55], s16 offen offset:64 sc1
    s_branch L_back_31
L_far_36:
    buffer_store_dword v4, v2, s[24:27], s20 offen offset:0 sc1
    s_branch L_back_37
L_far_38:
    buffer_store_dword v4, v2, s[24:27], s20 offen offset:512 sc1
    s_branch L_back_39
L_far_42:
    buffer_store_dword v4, v2, s[24:27], s20 offen offset:1024 sc1
    s_branch L_back_43
L_far_46:
    buffer_store_dwordx4 v[240:243], v1, s[24:27], s94 offen sc1
    s_branch L_back_47
L_far_50:
    buffer_store_dword v4, v2, s[24:27], s20 offen offset:1536 sc1
    s_branch L_back_51
L_far_52:
    buffer_store_dwordx4 v[240:243], v1, s[24:27], s95 offen sc1
    s_branch L_back_53
L_far_54:
    buffer_store_dword v4, v2, s[24:27], s20 offen offset:0 sc1
    s_branch L_back_55
L_far_62:
    buffer_store_dword v4, v2, s[52:55], s16 offen offset:64 sc1
    s_branch L_back_63
L_fb_slow:
    s_lshl_b32 s72, s64, 12
    s_add_u32 s72, s72, 0
    v_mov_b32 v227, v231
    s_mov_b32 exec_lo, 0
    v_lshl_add_u32 v227, v0, 7, s72
    s_mov_b32 exec_lo, -1
    s_mov_b32 s91, 0
L_fbs_90:
    s_sleep 8
    buffer_load_dwordx2 v[224:225], v227, s[24:27], 0 offen sc1
    s_waitcnt vmcnt(0)
    v_cmp_ne_u32 vcc, s66, v224
    s_add_u32 s91, s91, 1
    s_cbranch_vccz L_fbs_ok_91
    s_cmp_lt_u32 s91, 400000
    s_cbranch_scc1 L_fbs_90
L_fbs_ok_91:
    v_cmp_ne_u32 vcc, s67, v225
    s_cmp_eq_u32 vcc_hi, 0
    s_cselect_b32 s3, 1, 0
    s_branch L_fb_ok
L_redo:
    s_mov_b32 s69, 1
    s_mov_b32 s58, 0
    s_mov_b32 s38, 0
    v_subrev_u32 v233, 82944, v233
    s_sub_u32 s8, s8, 49152
    s_sub_u32 s21, s21, 32768
    s_waitcnt vmcnt(0) lgkmcnt(0)
    s_barrier
    v_mov_b32 v48, 0xff800000
    v_mov_b32 v49, 0xff800000
    v_mov_b32 v50, 0xff800000
    v_mov_b32 v51, 0xff800000
    s_lshl_b32 s72, s61, 16
    s_add_u32 s72, s72, 524288
    s_mov_b32 s73, 0
L_mp_loop:
    buffer_load_dwordx4 v[56:59], v1, s[24:27], s72 offen sc1
    buffer_load_dwordx4 v[60:63], v1, s[24:27], s72 offen offset:1024 sc1
    s_waitcnt vmcnt(0)
    v_mfma_f32_32x32x16_bf16 v[112:127], v[56:59], v[16:19], 0
    v_mfma_f32_32x32x16_bf16 v[112:127], v[60:63], v[20:23], v[112:127]
    s_nop 11
    v_max3_f32 v48, v48, v112, v113
    v_max3_f32 v48, v48, v114, v115
    v_max3_f32 v48, v48, v116, v117
    v_max3_f32 v48, v48, v118, v119
    v_max3_f32 v48, v48, v120, v121
    v_max3_f32 v48, v48, v122, v123
    v_max3_f32 v48, v48, v124, v125
    v_max3_f32 v48, v48, v126, v127
    v_mfma_f32_32x32x16_bf16 v[112:127], v[56:59], v[24:27], 0
    v_mfma_f32_32x32x16_bf16 v[112:127], v[60:63], v[28:31], v[112:127]
    s_nop 11
    v_max3_f32 v49, v49, v112, v113
    v_max3_f32 v49, v49, v114, v115
    v_max3_f32 v49, v49, v116, v117
    v_max3_f32 v49, v49, v118, v119
    v_max3_f32 v49, v49, v120, v121
    v_max3_f32 v49, v49, v122, v123
    v_max3_f32 v49, v49, v124, v125
    v_max3_f32 v49, v49, v126, v127
    v_mfma_f32_32x32x16_bf16 v[112:127], v[56:59], v[32:35], 0
    v_mfma_f32_32x32x16_bf16 v[112:127], v[60:63], v[36:39], v[112:127]
    s_nop 11
    v_max3_f32 v50, v50, v112, v113
    v_max3_f32 v50, v50, v114, v115
    v_max3_f32 v50, v50, v116, v117
    v_max3_f32 v50, v50, v118, v119
    v_max3_f32 v50, v50, v120, v121
    v_max3_f32 v50, v50, v122, v123
    v_max3_f32 v50, v50, v124, v125
    v_max3_f32 v50, v50, v126, v127
    v_mfma_f32_32x32x16_bf16 v[112:127], v[56:59], v[40:43], 0
    v_mfma_f32_32x32x16_bf16 v[112:127], v[60:63], v[44:47], v[112:127]
    s_nop 11
    v_max3_f32 v51, v51, v112, v113
    v_max3_f32 v51, v51, v114, v115
    v_max3_f32 v51, v51, v116, v117
    v_max3_f32 v51, v51, v118, v119
    v_max3_f32 v51, v51, v120, v121
    v_max3_f32 v51, v51, v122, v123
    v_max3_f32 v51, v51, v124, v125
    v_max3_f32 v51, v51, v126, v127
    s_add_u32 s72, s72, 4096
    s_add_u32 s73, s73, 1
    s_cmp_lt_u32 s73, 16
    s_cbranch_scc1 L_mp_loop
    v_lshlrev_b32 v64, 2, v0
    s_add_u32 s72, s61, 1
    s_and_b32 s72, s72, 3
    s_lshl_b32 s72, s72, 10
    s_add_u32 s72, s72, 114688
    v_and_b32 v65, 31, v0
    v_lshl_add_u32 v68, v65, 2, s72
    s_lshl_b32 s73, s61, 8
    s_add_u32 s72, s72, s73
    v_add_u32 v65, s72, v64
    ds_write_b32 v65, v48
    s_add_u32 s72, s61, 2
    s_and_b32 s72, s72, 3
    s_lshl_b32 s72, s72, 10
    s_add_u32 s72, s72, 114688
    v_and_b32 v65, 31, v0
    v_lshl_add_u32 v69, v65, 2, s72
    s_lshl_b32 s73, s61, 8
    s_add_u32 s72, s72, s73
    v_add_u32 v65, s72, v64
    ds_write_b32 v65, v49
    s_add_u32 s72, s61, 3
    s_and_b32 s72, s72, 3
    s_lshl_b32 s72, s72, 10
    s_add_u32 s72, s72, 114688
    v_and_b32 v65, 31, v0
    v_lshl_add_u32 v70, v65, 2, s72
    s_lshl_b32 s73, s61, 8
    s_add_u32 s72, s72, s73
    v_add_u32 v65, s72, v64
    ds_write_b32 v65, v50
    s_add_u32 s72, s61, 4
    s_and_b32 s72, s72, 3
    s_lshl_b32 s72, s72, 10
    s_add_u32 s72, s72, 114688
    v_and_b32 v65, 31, v0
    v_lshl_add_u32 v71, v65, 2, s72
    s_lshl_b32 s73, s61, 8
    s_add_u32 s72, s72, s73
    v_add_u32 v65, s72, v64
    ds_write_b32 v65, v51
    s_waitcnt lgkmcnt(0)
    s_barrier
    ds_read_b32 v72, v68 offset:0
    ds_read_b32 v73, v68 offset:128
    ds_read_b32 v74, v68 offset:256
    ds_read_b32 v75, v68 offset:384
    ds_read_b32 v76, v68 offset:512
    ds_read_b32 v77, v68 offset:640
    ds_read_b32 v78, v68 offset:768
    ds_read_b32 v79, v68 offset:896
    s_waitcnt lgkmcnt(0)
    v_max3_f32 v72, v72, v73, v74
    v_max3_f32 v72, v72, v75, v76
    v_max3_f32 v72, v72, v77, v78
    v_max_f32 v72, v72, v79
    v_sub_f32 v72, 0, v72
    v_and_b32 v73, 0xffff0000, v72
    v_sub_f32 v72, v72, v73
    v_and_b32 v74, 0xffff0000, v72
    v_sub_f32 v72, v72, v74
    v_lshrrev_b32 v73, 16, v73
    v_or_b32 v73, v73, v74
    v_lshrrev_b32 v72, 16, v72
    s_mov_b32 exec_lo, 0
    v_mov_b32 v22, v73
    v_mov_b32 v23, v72
    s_mov_b32 exec_lo, -1
    ds_read_b32 v72, v69 offset:0
    ds_read_b32 v73, v69 offset:128
    ds_read_b32 v74, v69 offset:256
    ds_read_b32 v75, v69 offset:384
    ds_read_b32 v76, v69 offset:512
    ds_read_b32 v77, v69 offset:640
    ds_read_b32 v78, v69 offset:768
    ds_read_b32 v79, v69 offset:896
    s_waitcnt lgkmcnt(0)
    v_max3_f32 v72, v72, v73, v74
    v_max3_f32 v72, v72, v75, v76
    v_max3_f32 v72, v72, v77, v78
    v_max_f32 v72, v72, v79
    v_sub_f32 v72, 0, v72
    v_and_b32 v73, 0xffff0000, v72
    v_sub_f32 v72, v72, v73
    v_and_b32 v74, 0xffff0000, v72
    v_sub_f32 v72, v72, v74
    v_lshrrev_b32 v73, 16, v73
    v_or_b32 v73, v73, v74
    v_lshrrev_b32 v72, 16, v72
    s_mov_b32 exec_lo, 0
    v_mov_b32 v30, v73
    v_mov_b32 v31, v72
    s_mov_b32 exec_lo, -1
    ds_read_b32 v72, v70 offset:0
    ds_read_b32 v73, v70 offset:128
    ds_read_b32 v74, v70 offset:256
    ds_read_b32 v75, v70 offset:384
    ds_read_b32 v76, v70 offset:512
    ds_read_b32 v77, v70 offset:640
    ds_read_b32 v78, v70 offset:768
    ds_read_b32 v79, v70 offset:896
    s_waitcnt lgkmcnt(0)
    v_max3_f32 v72, v72, v73, v74
    v_max3_f32 v72, v72, v75, v76
    v_max3_f32 v72, v72, v77, v78
    v_max_f32 v72, v72, v79
    v_sub_f32 v72, 0, v72
    v_and_b32 v73, 0xffff0000, v72
    v_sub_f32 v72, v72, v73
    v_and_b32 v74, 0xffff0000, v72
    v_sub_f32 v72, v72, v74
    v_lshrrev_b32 v73, 16, v73
    v_or_b32 v73, v73, v74
    v_lshrrev_b32 v72, 16, v72
    s_mov_b32 exec_lo, 0
    v_mov_b32 v38, v73
    v_mov_b32 v39, v72
    s_mov_b32 exec_lo, -1
    ds_read_b32 v72, v71 offset:0
    ds_read_b32 v73, v71 offset:128
    ds_read_b32 v74, v71 offset:256
    ds_read_b32 v75, v71 offset:384
    ds_read_b32 v76, v71 offset:512
    ds_read_b32 v77, v71 offset:640
    ds_read_b32 v78, v71 offset:768
    ds_read_b32 v79, v71 offset:896
    s_waitcnt lgkmcnt(0)
    v_max3_f32 v72, v72, v73, v74
    v_max3_f32 v72, v72, v75, v76
    v_max3_f32 v72, v72, v77, v78
    v_max_f32 v72, v72, v79
    v_sub_f32 v72, 0, v72
    v_and_b32 v73, 0xffff0000, v72
    v_sub_f32 v72, v72, v73
    v_and_b32 v74, 0xffff0000, v72
    v_sub_f32 v72, v72, v74
    v_lshrrev_b32 v73, 16, v73
    v_or_b32 v73, v73, v74
    v_lshrrev_b32 v72, 16, v72
    s_mov_b32 exec_lo, 0
    v_mov_b32 v46, v73
    v_mov_b32 v47, v72
    s_mov_b32 exec_lo, -1
    v_mov_b64 v[48:49], 0
    v_mov_b64 v[50:51], 0
    v_mov_b64 v[52:53], 0
    v_mov_b64 v[54:55], 0
    v_mov_b64 v[56:57], 0
    v_mov_b64 v[58:59], 0
    v_mov_b64 v[60:61], 0
    v_mov_b64 v[62:63], 0
    v_mov_b64 v[64:65], 0
    v_mov_b64 v[66:67], 0
    v_mov_b64 v[68:69], 0
    v_mov_b64 v[70:71], 0
    v_mov_b64 v[72:73], 0
    v_mov_b64 v[74:75], 0
    v_mov_b64 v[76:77], 0
    v_mov_b64 v[78:79], 0
    v_mov_b64 v[80:81], 0
    v_mov_b64 v[82:83], 0
    v_mov_b64 v[84:85], 0
    v_mov_b64 v[86:87], 0
    v_mov_b64 v[88:89], 0
    v_mov_b64 v[90:91], 0
    v_mov_b64 v[92:93], 0
    v_mov_b64 v[94:95], 0
    v_mov_b64 v[96:97], 0
    v_mov_b64 v[98:99], 0
    v_mov_b64 v[100:101], 0
    v_mov_b64 v[102:103], 0
    v_mov_b64 v[104:105], 0
    v_mov_b64 v[106:107], 0
    v_mov_b64 v[108:109], 0
    v_mov_b64 v[110:111], 0
    s_barrier
    buffer_load_dwordx4 v[160:163], v1, s[24:27], s7 offen offset:0 sc1
    buffer_load_dwordx4 v[164:167], v1, s[24:27], s7 offen offset:1024 sc1
    buffer_load_dwordx4 v[168:171], v1, s[24:27], s7 offen offset:2048 sc1
    buffer_load_dwordx4 v[172:175], v1, s[24:27], s7 offen offset:3072 sc1
    buffer_load_dwordx4 v[176:179], v3, s[24:27], s7 offen offset:0 sc1
    buffer_load_dwordx4 v[180:183], v3, s[24:27], s7 offen offset:1024 sc1
    buffer_load_dwordx4 v[184:187], v3, s[24:27], s7 offen offset:2048 sc1
    buffer_load_dwordx4 v[188:191], v3, s[24:27], s7 offen offset:3072 sc1
    s_add_u32 s7, s7, 32768
    s_and_b32 s7, s7, 786431
    s_waitcnt vmcnt(0) lgkmcnt(0)
    s_branch L_attn_main
L_exit:
    s_endpgm
.section .rodata,"a"
.p2align 6
.amdhsa_kernel sequential_preLN__grouped_kv_mqa__geglu_ffn__prompt_kernel
  .amdhsa_next_free_vgpr 512
  .amdhsa_next_free_sgpr 102
  .amdhsa_accum_offset 256
  .amdhsa_group_segment_fixed_size 0
  .amdhsa_kernarg_size 96
  .amdhsa_user_sgpr_count 2
  .amdhsa_user_sgpr_kernarg_segment_ptr 1
  .amdhsa_system_sgpr_workgroup_id_x 1
.end_amdhsa_kernel
```
